```python
import torch

def _softmax(x, axis=-1):
    return torch.softmax(x, dim=axis)
def _gelu(x):
    return torch.nn.functional.gelu(x, approximate="tanh")
def _silu(x):
    return torch.nn.functional.silu(x)
def _sigmoid(x):
    return torch.sigmoid(x)
def _layernorm(x, axis=-1, eps=1e-5):
    m = x.mean(dim=axis, keepdim=True)
    v = x.var(dim=axis, keepdim=True, unbiased=False)
    return (x - m) / torch.sqrt(v + eps)
def _scatter_add(tgt, idx, src, axis=0):
    return tgt.clone().index_add_(axis, idx, src)
def _segment_sum(src, seg, n):
    out = torch.zeros((n,) + src.shape[1:], dtype=src.dtype)
    return out.index_add_(0, seg, src)
def _pad(x, pw):
    flat = tuple(v for pair in reversed(pw) for v in pair)
    return torch.nn.functional.pad(x, flat)

kernel_name = 'interleave_layers__sliding_local_dilated__swiglu_ffn__prompt'

def setup_inputs():

    _w = (lambda a: (lambda t: t.to(torch.bfloat16) if t.is_floating_point() else t)(torch.as_tensor(a)))
    def _A_setup():
        B, S, D = 1, 2048, 576
        return {
            "x": _w((lambda *s: torch.randn(*s, dtype=torch.bfloat16) * 0.05)(B, S, D)),
            "wqkv": _w((lambda *s: torch.randn(*s, dtype=torch.bfloat16) * 0.05)(D, 3 * D)),
            "wo": _w((lambda *s: torch.randn(*s, dtype=torch.bfloat16) * 0.05)(D, D)),
        }
    _A_in = _A_setup()

    def _B_setup():
        B, S, D, F = 1, 2048, 576, 4608
        return {
            "x": _w((lambda *s: torch.randn(*s, dtype=torch.bfloat16) * 0.05)(B, S, D)),
            "w_gate": _w((lambda *s: torch.randn(*s, dtype=torch.bfloat16) * 0.05)(D, F)),
            "w_up": _w((lambda *s: torch.randn(*s, dtype=torch.bfloat16) * 0.05)(D, F)),
            "w_down": _w((lambda *s: torch.randn(*s, dtype=torch.bfloat16) * 0.05)(F, D)),
        }
    _B_in = _B_setup()

    return {
        "A_x": _A_in["x"],
        "A_wqkv": _A_in["wqkv"],
        "A_wo": _A_in["wo"],
        "B_x": _B_in["x"],
        "B_w_gate": _B_in["w_gate"],
        "B_w_up": _B_in["w_up"],
        "B_w_down": _B_in["w_down"],
    }

def reference(A_x, A_wqkv, A_wo, B_x, B_w_gate, B_w_up, B_w_down):
    def _A_ref(x, wqkv, wo):
        B, S, D = x.shape
        H = 32; Dh = D // H
        W, dil = 8, 2
        qkv = (lambda x, *d: x.permute(*d))((x @ wqkv).reshape(B, S, 3, H, Dh), 2, 0, 3, 1, 4)
        q, k, v = qkv[0], qkv[1], qkv[2]
        scale = Dh ** -0.5
        pos = torch.arange(S)
        off = torch.arange(W) * dil
        idx = pos[:, None] - off[None, :]
        mask = idx >= 0
        idx_c = torch.where(mask, idx, 0).reshape(-1)
        kg = k[:, :, idx_c, :].reshape(B, H, S, W, Dh)
        vg = v[:, :, idx_c, :].reshape(B, H, S, W, Dh)
        logits = torch.einsum("bhsd,bhswd->bhsw", q, kg) * scale
        logits = torch.where(mask[None, None, :, :], logits, -1e9)
        attn = _softmax(logits, axis=-1)
        o = torch.einsum("bhsw,bhswd->bhsd", attn, vg)
        return (lambda x, *d: x.permute(*d))(o, 0, 2, 1, 3).reshape(B, S, D) @ wo

    def _B_ref(x, w_gate, w_up, w_down):
        g = _silu(x @ w_gate)
        u = x @ w_up
        return (g * u) @ w_down

    x = A_x
    x = x + _A_ref(_layernorm(x, axis=-1), A_wqkv, A_wo)
    x = x + _B_ref(_layernorm(x, axis=-1), B_w_gate, B_w_up, B_w_down)
    x = x + _A_ref(_layernorm(x, axis=-1), A_wqkv, A_wo)
    x = x + _B_ref(_layernorm(x, axis=-1), B_w_gate, B_w_up, B_w_down)
    return x
```

```asm
; @launch grid=(256,1,1) block=(768,1,1) lds=139264
.amdgcn_target "amdgcn-amd-amdhsa--gfx950"
.text
.p2align 8
.globl interleave_layers__sliding_local_dilated__swiglu_ffn__prompt_kernel
.type interleave_layers__sliding_local_dilated__swiglu_ffn__prompt_kernel,@function
interleave_layers__sliding_local_dilated__swiglu_ffn__prompt_kernel:
    s_cmp_ge_u32 s2, 256
    s_cbranch_scc1 interleave_layers__sliding_local_dilated__swiglu_ffn__prompt_kernel_end
    s_load_dwordx2 s[28:29], s[0:1], 72
    v_lshrrev_b32 v1, 6, v0
    v_and_b32 v0, 63, v0
    v_readfirstlane_b32 s3, v1
    s_lshl_b32 s56, s3, 10
    s_waitcnt lgkmcnt(0)
    s_add_u32 s88, s28, 136314880
    s_addc_u32 s89, s29, 0
    s_and_b32 s89, s89, 0xffff
    s_mov_b32 s90, 393216
    s_mov_b32 s91, 0x00020000
    s_cmp_lt_u32 s3, 64
    s_cbranch_scc1 L1_codewarm
    s_getpc_b64 s[4:5]
mega_pc:
    s_sub_u32 s4, s4, mega_pc-interleave_layers__sliding_local_dilated__swiglu_ffn__prompt_kernel
    s_subb_u32 s5, s5, 0
    s_mov_b32 s20, s4
    s_and_b32 s21, s5, 0xffff
    s_mov_b32 s22, interleave_layers__sliding_local_dilated__swiglu_ffn__prompt_kernel_end-interleave_layers__sliding_local_dilated__swiglu_ffn__prompt_kernel
    s_mov_b32 s23, 0x00020000
    s_sub_u32 s4, s3, 8
    s_lshl_b32 s4, s4, 6
    v_add_u32 v1, s4, v0
    v_lshlrev_b32 v1, 7, v1
    s_mov_b32 s4, 0
    buffer_load_dword v160, v1, s[20:23], s4 offen
    s_mov_b32 s4, 32768
    buffer_load_dword v161, v1, s[20:23], s4 offen
    s_mov_b32 s4, 65536
    buffer_load_dword v162, v1, s[20:23], s4 offen
L1_codewarm:
    s_add_u32 s4, s2, s3
    s_cmp_lg_u32 s4, 0
    s_cbranch_scc1 L2_nonce0
    s_load_dwordx2 s[4:5], s[0:1], 64
    s_memrealtime s[6:7]
    s_waitcnt lgkmcnt(0)
    s_mov_b32 s20, s4
    s_and_b32 s21, s5, 0xffff
    s_mov_b32 s22, 256
    s_mov_b32 s23, 0x00020000
    s_or_b32 s6, s6, 1
    v_mov_b32 v1, 0
    v_mov_b32 v2, s6
    v_mov_b32 v3, s7
    s_mov_b64 exec, 1
    buffer_store_dwordx2 v[2:3], v1, s[20:23], 0 offen sc1
    s_mov_b64 exec, -1
L2_nonce0:
    s_mov_b32 s99, 0
layer_top:
    s_load_dwordx2 s[64:65], s[0:1], 8
    s_and_b32 s68, s2, 7
    s_lshr_b32 s69, s2, 3
    s_lshr_b32 s70, s68, 1
    s_lshl_b32 s70, s70, 2
    s_and_b32 s71, s69, 3
    s_add_u32 s70, s70, s71
    s_and_b32 s68, s68, 1
    s_lshl_b32 s68, s68, 3
    s_lshr_b32 s69, s69, 2
    s_add_u32 s69, s69, s68
    s_mov_b32 s68, s70
    s_mul_i32 s61, s68, 147456
    s_sub_u32 s61, s61, 18432
    s_mul_i32 s63, s3, 21846
    s_lshr_b32 s63, s63, 16
    s_mul_i32 s62, s63, 3
    s_sub_u32 s62, s3, s62
    v_lshrrev_b32 v3, 3, v0
    v_xor_b32 v2, v3, v0
    v_and_b32 v2, 7, v2
    v_lshlrev_b32 v2, 4, v2
    s_mov_b32 s5, 1152
    v_mul_lo_u32 v3, v3, s5
    v_add_u32 v50, v2, v3
    v_add_u32 v50, s61, v50
    s_add_u32 s4, s3, 0
    s_mul_i32 s5, s4, 9216
    v_add_u32 v2, s5, v50
    s_sub_u32 s5, s4, 18
    s_cmp_ge_u32 s5, 8
    s_cselect_b32 s6, 8, 0
    s_cselect_b32 s7, 110592, 0
    s_sub_u32 s5, s5, s6
    s_cmp_ge_u32 s5, 8
    s_cselect_b32 s6, 8, 0
    s_sub_u32 s5, s5, s6
    s_lshl_b32 s5, s5, 2
    v_lshrrev_b32 v4, 4, v0
    v_add_u32 v4, s5, v4
    v_and_b32 v5, 15, v0
    v_lshrrev_b32 v6, 1, v5
    v_and_b32 v7, 7, v4
    v_xor_b32 v6, v6, v7
    v_and_b32 v5, 1, v5
    v_lshl_add_u32 v5, v6, 1, v5
    v_min_u32 v5, 14, v5
    v_mul_u32_u24 v6, 13108, v5
    v_lshrrev_b32 v6, 16, v6
    v_mul_u32_u24 v7, 5, v6
    v_sub_u32 v5, v5, v7
    v_lshlrev_b32 v5, 4, v5
    v_mul_u32_u24 v6, 1152, v6
    v_add_u32 v5, v5, v6
    v_and_b32 v6, 0x13, v4
    v_and_b32 v7, 4, v4
    v_lshl_or_b32 v6, v7, 1, v6
    v_and_b32 v7, 8, v4
    v_lshrrev_b32 v7, 1, v7
    v_or_b32 v6, v6, v7
    s_mov_b32 s5, 3456
    v_mul_lo_u32 v6, v6, s5
    v_add3_u32 v5, v5, v6, s7
    s_cmp_lt_u32 s4, 18
    s_cselect_b64 vcc, -1, 0
    v_cndmask_b32 v74, v5, v2, vcc
    s_cselect_b32 s78, 2, 3456
    s_lshl_b32 s78, s78, 6
    s_mov_b32 s72, 0
    s_add_u32 s4, s3, 12
    s_mul_i32 s5, s4, 9216
    v_add_u32 v2, s5, v50
    s_sub_u32 s5, s4, 18
    s_cmp_ge_u32 s5, 8
    s_cselect_b32 s6, 8, 0
    s_cselect_b32 s7, 110592, 0
    s_sub_u32 s5, s5, s6
    s_cmp_ge_u32 s5, 8
    s_cselect_b32 s6, 8, 0
    s_sub_u32 s5, s5, s6
    s_lshl_b32 s5, s5, 2
    v_lshrrev_b32 v4, 4, v0
    v_add_u32 v4, s5, v4
    v_and_b32 v5, 15, v0
    v_lshrrev_b32 v6, 1, v5
    v_and_b32 v7, 7, v4
    v_xor_b32 v6, v6, v7
    v_and_b32 v5, 1, v5
    v_lshl_add_u32 v5, v6, 1, v5
    v_min_u32 v5, 14, v5
    v_mul_u32_u24 v6, 13108, v5
    v_lshrrev_b32 v6, 16, v6
    v_mul_u32_u24 v7, 5, v6
    v_sub_u32 v5, v5, v7
    v_lshlrev_b32 v5, 4, v5
    v_mul_u32_u24 v6, 1152, v6
    v_add_u32 v5, v5, v6
    v_and_b32 v6, 0x13, v4
    v_and_b32 v7, 4, v4
    v_lshl_or_b32 v6, v7, 1, v6
    v_and_b32 v7, 8, v4
    v_lshrrev_b32 v7, 1, v7
    v_or_b32 v6, v6, v7
    s_mov_b32 s5, 3456
    v_mul_lo_u32 v6, v6, s5
    v_add3_u32 v5, v5, v6, s7
    s_cmp_lt_u32 s4, 18
    s_cselect_b64 vcc, -1, 0
    v_cndmask_b32 v75, v5, v2, vcc
    s_cselect_b32 s79, 2, 3456
    s_lshl_b32 s79, s79, 6
    s_mov_b32 s73, 0
    s_add_u32 s4, s3, 24
    s_mul_i32 s5, s4, 9216
    v_add_u32 v2, s5, v50
    s_sub_u32 s5, s4, 18
    s_cmp_ge_u32 s5, 8
    s_cselect_b32 s6, 8, 0
    s_cselect_b32 s7, 110592, 0
    s_sub_u32 s5, s5, s6
    s_cmp_ge_u32 s5, 8
    s_cselect_b32 s6, 8, 0
    s_sub_u32 s5, s5, s6
    s_lshl_b32 s5, s5, 2
    v_lshrrev_b32 v4, 4, v0
    v_add_u32 v4, s5, v4
    v_and_b32 v5, 15, v0
    v_lshrrev_b32 v6, 1, v5
    v_and_b32 v7, 7, v4
    v_xor_b32 v6, v6, v7
    v_and_b32 v5, 1, v5
    v_lshl_add_u32 v5, v6, 1, v5
    v_min_u32 v5, 14, v5
    v_mul_u32_u24 v6, 13108, v5
    v_lshrrev_b32 v6, 16, v6
    v_mul_u32_u24 v7, 5, v6
    v_sub_u32 v5, v5, v7
    v_lshlrev_b32 v5, 4, v5
    v_mul_u32_u24 v6, 1152, v6
    v_add_u32 v5, v5, v6
    v_and_b32 v6, 0x13, v4
    v_and_b32 v7, 4, v4
    v_lshl_or_b32 v6, v7, 1, v6
    v_and_b32 v7, 8, v4
    v_lshrrev_b32 v7, 1, v7
    v_or_b32 v6, v6, v7
    s_mov_b32 s5, 3456
    v_mul_lo_u32 v6, v6, s5
    v_add3_u32 v5, v5, v6, s7
    s_cmp_lt_u32 s4, 18
    s_cselect_b64 vcc, -1, 0
    v_cndmask_b32 v76, v5, v2, vcc
    s_cselect_b32 s80, 2, 3456
    s_lshl_b32 s80, s80, 6
    s_mov_b32 s74, 0
    s_cmp_ge_u32 s4, 34
    s_cselect_b32 s57, 1, 0
    v_lshrrev_b32 v3, 4, v0
    v_xor_b32 v2, v3, v0
    v_and_b32 v2, 7, v2
    v_lshlrev_b32 v2, 4, v2
    v_and_b32 v3, 15, v0
    v_lshl_add_u32 v2, v3, 7, v2
    s_mul_i32 s4, s62, 6144
    v_add_u32 v2, s4, v2
    v_xor_b32 v3, 64, v2
    v_add_u32 v58, 0, v2
    v_add_u32 v59, 0, v3
    v_add_u32 v60, 34816, v2
    v_add_u32 v61, 34816, v3
    v_add_u32 v62, 69632, v2
    v_add_u32 v63, 69632, v3
    v_add_u32 v64, 104448, v2
    v_add_u32 v65, 104448, v3
    v_lshrrev_b32 v3, 5, v0
    v_lshlrev_b32 v3, 4, v3
    v_bfe_u32 v4, v0, 4, 1
    v_lshl_add_u32 v3, v4, 2, v3
    v_bfe_u32 v4, v0, 2, 2
    v_add_u32 v3, v3, v4
    v_and_b32 v5, 3, v0
    v_lshlrev_b32 v5, 3, v5
    v_and_b32 v7, 7, v3
    s_mul_i32 s4, s63, 2
    s_add_u32 s4, s4, 0
    v_xor_b32 v6, s4, v7
    v_lshlrev_b32 v6, 5, v6
    v_lshl_add_u32 v6, v3, 8, v6
    v_add_u32 v6, v6, v5
    v_add_u32 v66, 18432, v6
    v_add_u32 v68, 53248, v6
    v_add_u32 v70, 88064, v6
    v_add_u32 v72, 122880, v6
    s_mul_i32 s4, s63, 2
    s_add_u32 s4, s4, 1
    v_xor_b32 v6, s4, v7
    v_lshlrev_b32 v6, 5, v6
    v_lshl_add_u32 v6, v3, 8, v6
    v_add_u32 v6, v6, v5
    v_add_u32 v67, 18432, v6
    v_add_u32 v69, 53248, v6
    v_add_u32 v71, 88064, v6
    v_add_u32 v73, 122880, v6
    s_waitcnt lgkmcnt(0)
    s_add_u32 s8, s28, 0
    s_addc_u32 s9, s29, 0
    s_and_b32 s9, s9, 0xffff
    s_mov_b32 s10, 2359296
    s_mov_b32 s11, 0x00020000
    s_mul_i32 s6, s69, 72
    s_add_u32 s12, s64, s6
    s_addc_u32 s13, s65, 0
    s_and_b32 s13, s13, 0xffff
    s_mov_b32 s14, 0
    s_mov_b32 s15, 0x00020000
    s_sub_u32 s14, 1990656, s6
    s_mov_b32 s16, s12
    s_mov_b32 s17, s13
    s_mov_b32 s18, s14
    s_mov_b32 s19, s15
    s_add_u32 s20, s28, 8388608
    s_addc_u32 s21, s29, 0
    s_and_b32 s21, s21, 0xffff
    s_mov_b32 s22, 2359296
    s_mov_b32 s23, 0x00020000
    s_add_u32 s4, s3, 0
    s_sub_u32 s5, s4, 18
    s_cmp_ge_u32 s5, 8
    s_cselect_b32 s6, 8, 0
    s_sub_u32 s5, s5, s6
    s_cmp_ge_u32 s5, 8
    s_cselect_b32 s32, s16, s12
    s_cselect_b32 s33, s17, s13
    s_cselect_b32 s34, s18, s14
    s_cselect_b32 s35, s19, s15
    s_cmp_lt_u32 s4, 18
    s_cselect_b32 s32, s8, s32
    s_cselect_b32 s33, s9, s33
    s_cselect_b32 s34, s10, s34
    s_cselect_b32 s35, s11, s35
    s_add_u32 s4, s3, 12
    s_sub_u32 s5, s4, 18
    s_cmp_ge_u32 s5, 8
    s_cselect_b32 s6, 8, 0
    s_sub_u32 s5, s5, s6
    s_cmp_ge_u32 s5, 8
    s_cselect_b32 s36, s16, s12
    s_cselect_b32 s37, s17, s13
    s_cselect_b32 s38, s18, s14
    s_cselect_b32 s39, s19, s15
    s_cmp_lt_u32 s4, 18
    s_cselect_b32 s36, s8, s36
    s_cselect_b32 s37, s9, s37
    s_cselect_b32 s38, s10, s38
    s_cselect_b32 s39, s11, s39
    s_add_u32 s4, s3, 24
    s_sub_u32 s5, s4, 18
    s_cmp_ge_u32 s5, 8
    s_cselect_b32 s6, 8, 0
    s_sub_u32 s5, s5, s6
    s_cmp_ge_u32 s5, 8
    s_cselect_b32 s40, s16, s12
    s_cselect_b32 s41, s17, s13
    s_cselect_b32 s42, s18, s14
    s_cselect_b32 s43, s19, s15
    s_cmp_lt_u32 s4, 18
    s_cselect_b32 s40, s8, s40
    s_cselect_b32 s41, s9, s41
    s_cselect_b32 s42, s10, s42
    s_cselect_b32 s43, s11, s43
    s_cmp_eq_u32 s99, 0
    s_cbranch_scc1 L3_nopp
    s_waitcnt vmcnt(0)
    s_barrier
    s_cmp_lg_u32 s3, 0
    s_cbranch_scc1 L4_pub
    s_lshl_b32 s4, s31, 7
    s_add_u32 s4, s4, 262144
    v_mov_b32 v1, s4
    v_mov_b32 v2, s100
    v_mov_b32 v3, s101
    s_mov_b64 exec, 1
    buffer_store_dwordx2 v[2:3], v1, s[88:91], 0 offen sc1
    s_mov_b64 exec, -1
L4_pub:
L3_nopp:
    s_add_u32 s4, s3, 0
    s_cmp_lt_u32 s4, 18
    s_cbranch_scc1 L5_t
    s_add_u32 m0, s56, 0
    s_nop 0
    buffer_load_dwordx4 v74, s[32:35], s72 offen lds
    s_add_u32 s72, s72, s78
    s_add_u32 m0, s56, 34816
    s_nop 0
    buffer_load_dwordx4 v74, s[32:35], s72 offen lds
    s_add_u32 s72, s72, s78
    s_add_u32 m0, s56, 69632
    s_nop 0
    buffer_load_dwordx4 v74, s[32:35], s72 offen lds
    s_add_u32 s72, s72, s78
    s_add_u32 m0, s56, 104448
    s_nop 0
    buffer_load_dwordx4 v74, s[32:35], s72 offen lds
    s_add_u32 s72, s72, s78
L5_t:
    s_add_u32 s4, s3, 12
    s_cmp_lt_u32 s4, 18
    s_cbranch_scc1 L6_t
    s_add_u32 m0, s56, 12288
    s_nop 0
    buffer_load_dwordx4 v75, s[36:39], s73 offen lds
    s_add_u32 s73, s73, s79
    s_add_u32 m0, s56, 47104
    s_nop 0
    buffer_load_dwordx4 v75, s[36:39], s73 offen lds
    s_add_u32 s73, s73, s79
    s_add_u32 m0, s56, 81920
    s_nop 0
    buffer_load_dwordx4 v75, s[36:39], s73 offen lds
    s_add_u32 s73, s73, s79
    s_add_u32 m0, s56, 116736
    s_nop 0
    buffer_load_dwordx4 v75, s[36:39], s73 offen lds
    s_add_u32 s73, s73, s79
L6_t:
    s_add_u32 s4, s3, 24
    s_cmp_lt_u32 s4, 18
    s_cbranch_scc1 L7_t
    s_cmp_eq_u32 s57, 1
    s_cbranch_scc1 L8_d
    s_add_u32 m0, s56, 24576
    s_nop 0
    buffer_load_dwordx4 v76, s[40:43], s74 offen lds
    s_add_u32 s74, s74, s80
L8_d:
    s_cmp_eq_u32 s57, 1
    s_cbranch_scc1 L9_d
    s_add_u32 m0, s56, 59392
    s_nop 0
    buffer_load_dwordx4 v76, s[40:43], s74 offen lds
    s_add_u32 s74, s74, s80
L9_d:
    s_cmp_eq_u32 s57, 1
    s_cbranch_scc1 L10_d
    s_add_u32 m0, s56, 94208
    s_nop 0
    buffer_load_dwordx4 v76, s[40:43], s74 offen lds
    s_add_u32 s74, s74, s80
L10_d:
    s_cmp_eq_u32 s57, 1
    s_cbranch_scc1 L11_d
    s_add_u32 m0, s56, 129024
    s_nop 0
    buffer_load_dwordx4 v76, s[40:43], s74 offen lds
    s_add_u32 s74, s74, s80
L11_d:
L7_t:
    v_and_b32 v2, 15, v0
    s_mul_i32 s4, s62, 48
    v_add_u32 v2, s4, v2
    v_mul_u32_u24 v2, 304, v2
    v_mov_b32 v7, 288
    s_mul_i32 s4, s63, 32
    s_add_u32 s4, s4, 0
    v_lshrrev_b32 v3, 4, v0
    v_lshl_add_u32 v3, v3, 2, s4
    v_mul_u32_u24 v4, 1639, v3
    v_lshrrev_b32 v4, 16, v4
    v_mul_u32_u24 v5, 40, v4
    v_sub_u32 v5, v3, v5
    v_cmp_le_u32 vcc, 18, v5
    s_nop 1
    v_cndmask_b32 v6, 0, 1, vcc
    v_mul_u32_u24 v1, 18, v6
    v_sub_u32 v1, v5, v1
    v_lshl_add_u32 v6, v4, 1, v6
    v_mul_u32_u24 v6, 48, v6
    v_lshl_add_u32 v6, v1, 1, v6
    v_cmp_le_u32 vcc, 36, v5
    s_nop 1
    v_cndmask_b32 v6, v6, v7, vcc
    v_cmp_le_u32 vcc, 120, v3
    s_nop 1
    v_cndmask_b32 v6, v6, v7, vcc
    v_add_u32 v152, v6, v2
    s_mul_i32 s4, s63, 32
    s_add_u32 s4, s4, 2
    v_lshrrev_b32 v3, 4, v0
    v_lshl_add_u32 v3, v3, 2, s4
    v_mul_u32_u24 v4, 1639, v3
    v_lshrrev_b32 v4, 16, v4
    v_mul_u32_u24 v5, 40, v4
    v_sub_u32 v5, v3, v5
    v_cmp_le_u32 vcc, 18, v5
    s_nop 1
    v_cndmask_b32 v6, 0, 1, vcc
    v_mul_u32_u24 v1, 18, v6
    v_sub_u32 v1, v5, v1
    v_lshl_add_u32 v6, v4, 1, v6
    v_mul_u32_u24 v6, 48, v6
    v_lshl_add_u32 v6, v1, 1, v6
    v_cmp_le_u32 vcc, 36, v5
    s_nop 1
    v_cndmask_b32 v6, v6, v7, vcc
    v_cmp_le_u32 vcc, 120, v3
    s_nop 1
    v_cndmask_b32 v6, v6, v7, vcc
    v_add_u32 v153, v6, v2
    s_mul_i32 s4, s63, 32
    s_add_u32 s4, s4, 16
    v_lshrrev_b32 v3, 4, v0
    v_lshl_add_u32 v3, v3, 2, s4
    v_mul_u32_u24 v4, 1639, v3
    v_lshrrev_b32 v4, 16, v4
    v_mul_u32_u24 v5, 40, v4
    v_sub_u32 v5, v3, v5
    v_cmp_le_u32 vcc, 18, v5
    s_nop 1
    v_cndmask_b32 v6, 0, 1, vcc
    v_mul_u32_u24 v1, 18, v6
    v_sub_u32 v1, v5, v1
    v_lshl_add_u32 v6, v4, 1, v6
    v_mul_u32_u24 v6, 48, v6
    v_lshl_add_u32 v6, v1, 1, v6
    v_cmp_le_u32 vcc, 36, v5
    s_nop 1
    v_cndmask_b32 v6, v6, v7, vcc
    v_cmp_le_u32 vcc, 120, v3
    s_nop 1
    v_cndmask_b32 v6, v6, v7, vcc
    v_add_u32 v154, v6, v2
    s_mul_i32 s4, s63, 32
    s_add_u32 s4, s4, 18
    v_lshrrev_b32 v3, 4, v0
    v_lshl_add_u32 v3, v3, 2, s4
    v_mul_u32_u24 v4, 1639, v3
    v_lshrrev_b32 v4, 16, v4
    v_mul_u32_u24 v5, 40, v4
    v_sub_u32 v5, v3, v5
    v_cmp_le_u32 vcc, 18, v5
    s_nop 1
    v_cndmask_b32 v6, 0, 1, vcc
    v_mul_u32_u24 v1, 18, v6
    v_sub_u32 v1, v5, v1
    v_lshl_add_u32 v6, v4, 1, v6
    v_mul_u32_u24 v6, 48, v6
    v_lshl_add_u32 v6, v1, 1, v6
    v_cmp_le_u32 vcc, 36, v5
    s_nop 1
    v_cndmask_b32 v6, v6, v7, vcc
    v_cmp_le_u32 vcc, 120, v3
    s_nop 1
    v_cndmask_b32 v6, v6, v7, vcc
    v_add_u32 v155, v6, v2
    s_sub_u32 s59, s68, 1
    s_max_i32 s59, s59, 0
    s_lshl_b32 s59, s59, 4
    s_cmp_lg_u32 s99, 0
    s_cbranch_scc1 L13_lnvar
    s_cmp_ge_u32 s3, 8
    s_cbranch_scc1 L14_lnskip
    s_load_dwordx2 s[6:7], s[0:1], 0
    s_waitcnt lgkmcnt(0)
    s_mov_b32 s84, s6
    s_and_b32 s85, s7, 0xffff
    s_mov_b32 s86, 2359296
    s_mov_b32 s87, 0x00020000
    s_add_u32 s20, s28, 0
    s_addc_u32 s21, s29, 0
    s_and_b32 s21, s21, 0xffff
    s_mov_b32 s22, 2359296
    s_mov_b32 s23, 0x00020000
    s_lshl_b32 s58, s2, 3
    s_add_u32 s58, s58, s3
    s_mul_i32 s64, s58, 1152
    v_lshlrev_b32 v2, 4, v0
    v_mov_b32 v8, 0
    v_mov_b32 v9, 0
    v_mov_b32 v10, 0
    v_mov_b32 v11, 0
    buffer_load_dwordx4 v[4:7], v2, s[84:87], s64 offen
    s_mov_b64 exec, 0xff
    buffer_load_dwordx4 v[8:11], v2, s[84:87], s64 offen offset:1024
    s_mov_b64 exec, -1
    s_waitcnt vmcnt(0)
    v_lshlrev_b32 v16, 16, v4
    v_and_b32 v17, 0xffff0000, v4
    v_lshlrev_b32 v18, 16, v5
    v_and_b32 v19, 0xffff0000, v5
    v_lshlrev_b32 v20, 16, v6
    v_and_b32 v21, 0xffff0000, v6
    v_lshlrev_b32 v22, 16, v7
    v_and_b32 v23, 0xffff0000, v7
    v_lshlrev_b32 v24, 16, v8
    v_and_b32 v25, 0xffff0000, v8
    v_lshlrev_b32 v26, 16, v9
    v_and_b32 v27, 0xffff0000, v9
    v_lshlrev_b32 v28, 16, v10
    v_and_b32 v29, 0xffff0000, v10
    v_lshlrev_b32 v30, 16, v11
    v_and_b32 v31, 0xffff0000, v11
    v_add_f32 v94, v16, v17
    v_add_f32 v94, v94, v18
    v_add_f32 v94, v94, v19
    v_add_f32 v94, v94, v20
    v_add_f32 v94, v94, v21
    v_add_f32 v94, v94, v22
    v_add_f32 v94, v94, v23
    v_add_f32 v94, v94, v24
    v_add_f32 v94, v94, v25
    v_add_f32 v94, v94, v26
    v_add_f32 v94, v94, v27
    v_add_f32 v94, v94, v28
    v_add_f32 v94, v94, v29
    v_add_f32 v94, v94, v30
    v_add_f32 v94, v94, v31
    s_nop 1
    v_add_f32_dpp v94, v94, v94 row_shr:1 row_mask:0xf bank_mask:0xf
    s_nop 1
    v_add_f32_dpp v94, v94, v94 row_shr:2 row_mask:0xf bank_mask:0xf
    s_nop 1
    v_add_f32_dpp v94, v94, v94 row_shr:4 row_mask:0xf bank_mask:0xf
    s_nop 1
    v_add_f32_dpp v94, v94, v94 row_shr:8 row_mask:0xf bank_mask:0xf
    s_nop 1
    v_add_f32_dpp v94, v94, v94 row_bcast:15 row_mask:0xa bank_mask:0xf
    s_nop 1
    v_add_f32_dpp v94, v94, v94 row_bcast:31 row_mask:0xc bank_mask:0xf
    s_nop 0
    v_readlane_b32 s70, v94, 63
    s_mov_b32 s71, 0x3ae38e39
    s_nop 0
    v_mov_b32 v95, s70
    v_mul_f32 v95, s71, v95
    v_mov_b32 v96, 0
    v_mov_b32 v97, 0
    v_sub_f32 v98, v16, v95
    v_fmac_f32 v96, v98, v98
    v_sub_f32 v98, v17, v95
    v_fmac_f32 v96, v98, v98
    v_sub_f32 v98, v18, v95
    v_fmac_f32 v96, v98, v98
    v_sub_f32 v98, v19, v95
    v_fmac_f32 v96, v98, v98
    v_sub_f32 v98, v20, v95
    v_fmac_f32 v96, v98, v98
    v_sub_f32 v98, v21, v95
    v_fmac_f32 v96, v98, v98
    v_sub_f32 v98, v22, v95
    v_fmac_f32 v96, v98, v98
    v_sub_f32 v98, v23, v95
    v_fmac_f32 v96, v98, v98
    s_mov_b64 exec, 0xff
    v_sub_f32 v98, v24, v95
    v_fmac_f32 v97, v98, v98
    v_sub_f32 v98, v25, v95
    v_fmac_f32 v97, v98, v98
    v_sub_f32 v98, v26, v95
    v_fmac_f32 v97, v98, v98
    v_sub_f32 v98, v27, v95
    v_fmac_f32 v97, v98, v98
    v_sub_f32 v98, v28, v95
    v_fmac_f32 v97, v98, v98
    v_sub_f32 v98, v29, v95
    v_fmac_f32 v97, v98, v98
    v_sub_f32 v98, v30, v95
    v_fmac_f32 v97, v98, v98
    v_sub_f32 v98, v31, v95
    v_fmac_f32 v97, v98, v98
    s_mov_b64 exec, -1
    v_add_f32 v96, v96, v97
    s_nop 1
    v_add_f32_dpp v96, v96, v96 row_shr:1 row_mask:0xf bank_mask:0xf
    s_nop 1
    v_add_f32_dpp v96, v96, v96 row_shr:2 row_mask:0xf bank_mask:0xf
    s_nop 1
    v_add_f32_dpp v96, v96, v96 row_shr:4 row_mask:0xf bank_mask:0xf
    s_nop 1
    v_add_f32_dpp v96, v96, v96 row_shr:8 row_mask:0xf bank_mask:0xf
    s_nop 1
    v_add_f32_dpp v96, v96, v96 row_bcast:15 row_mask:0xa bank_mask:0xf
    s_nop 1
    v_add_f32_dpp v96, v96, v96 row_bcast:31 row_mask:0xc bank_mask:0xf
    s_nop 0
    v_readlane_b32 s70, v96, 63
    s_nop 1
    v_mov_b32 v97, s70
    v_mul_f32 v97, s71, v97
    v_cvt_pk_bf16_f32 v98, v95, v97
    v_lshlrev_b32 v95, 16, v98
    v_and_b32 v97, 0xffff0000, v98
    v_add_f32 v97, 0x3727c5ac, v97
    v_cvt_pk_bf16_f32 v98, v97, v97
    v_lshlrev_b32 v97, 16, v98
    v_sqrt_f32 v97, v97
    s_nop 0
    v_cvt_pk_bf16_f32 v98, v97, v97
    v_lshlrev_b32 v97, 16, v98
    v_rcp_f32 v97, v97
    v_sub_f32 v16, v16, v95
    v_sub_f32 v17, v17, v95
    v_sub_f32 v18, v18, v95
    v_sub_f32 v19, v19, v95
    v_sub_f32 v20, v20, v95
    v_sub_f32 v21, v21, v95
    v_sub_f32 v22, v22, v95
    v_sub_f32 v23, v23, v95
    v_sub_f32 v24, v24, v95
    v_sub_f32 v25, v25, v95
    v_sub_f32 v26, v26, v95
    v_sub_f32 v27, v27, v95
    v_sub_f32 v28, v28, v95
    v_sub_f32 v29, v29, v95
    v_sub_f32 v30, v30, v95
    v_sub_f32 v31, v31, v95
    v_cvt_pk_bf16_f32 v102, v16, v17
    v_cvt_pk_bf16_f32 v103, v18, v19
    v_cvt_pk_bf16_f32 v104, v20, v21
    v_cvt_pk_bf16_f32 v105, v22, v23
    v_cvt_pk_bf16_f32 v106, v24, v25
    v_cvt_pk_bf16_f32 v107, v26, v27
    v_cvt_pk_bf16_f32 v108, v28, v29
    v_cvt_pk_bf16_f32 v109, v30, v31
    v_lshlrev_b32 v16, 16, v102
    v_and_b32 v17, 0xffff0000, v102
    v_lshlrev_b32 v18, 16, v103
    v_and_b32 v19, 0xffff0000, v103
    v_lshlrev_b32 v20, 16, v104
    v_and_b32 v21, 0xffff0000, v104
    v_lshlrev_b32 v22, 16, v105
    v_and_b32 v23, 0xffff0000, v105
    v_lshlrev_b32 v24, 16, v106
    v_and_b32 v25, 0xffff0000, v106
    v_lshlrev_b32 v26, 16, v107
    v_and_b32 v27, 0xffff0000, v107
    v_lshlrev_b32 v28, 16, v108
    v_and_b32 v29, 0xffff0000, v108
    v_lshlrev_b32 v30, 16, v109
    v_and_b32 v31, 0xffff0000, v109
    v_mul_f32 v16, v16, v97
    v_mul_f32 v17, v17, v97
    v_mul_f32 v18, v18, v97
    v_mul_f32 v19, v19, v97
    v_mul_f32 v20, v20, v97
    v_mul_f32 v21, v21, v97
    v_mul_f32 v22, v22, v97
    v_mul_f32 v23, v23, v97
    v_mul_f32 v24, v24, v97
    v_mul_f32 v25, v25, v97
    v_mul_f32 v26, v26, v97
    v_mul_f32 v27, v27, v97
    v_mul_f32 v28, v28, v97
    v_mul_f32 v29, v29, v97
    v_mul_f32 v30, v30, v97
    v_mul_f32 v31, v31, v97
    v_cvt_pk_bf16_f32 v102, v16, v17
    v_cvt_pk_bf16_f32 v103, v18, v19
    v_cvt_pk_bf16_f32 v104, v20, v21
    v_cvt_pk_bf16_f32 v105, v22, v23
    v_cvt_pk_bf16_f32 v106, v24, v25
    v_cvt_pk_bf16_f32 v107, v26, v27
    v_cvt_pk_bf16_f32 v108, v28, v29
    v_cvt_pk_bf16_f32 v109, v30, v31
    buffer_store_dwordx4 v[102:105], v2, s[20:23], s64 offen sc1
    s_mov_b64 exec, 0xff
    buffer_store_dwordx4 v[106:109], v2, s[20:23], s64 offen offset:1024 sc1
    s_mov_b64 exec, -1
L14_lnskip:
    s_cmp_lg_u32 s3, 0
    s_cbranch_scc1 L15_noncen
    s_load_dwordx2 s[4:5], s[0:1], 64
    s_waitcnt lgkmcnt(0)
    s_mov_b32 s20, s4
    s_and_b32 s21, s5, 0xffff
    s_mov_b32 s22, 256
    s_mov_b32 s23, 0x00020000
    v_mov_b32 v1, 0
    s_mov_b32 s5, 0
L15_nonce:
    buffer_load_dwordx2 v[2:3], v1, s[20:23], 0 offen sc1
    s_waitcnt vmcnt(0)
    v_readfirstlane_b32 s100, v2
    v_readfirstlane_b32 s101, v3
    s_add_u32 s5, s5, 1
    s_cmp_gt_u32 s5, 0x40000
    s_cbranch_scc1 L15_noncen
    s_cmp_lg_u32 s100, 0
    s_cbranch_scc1 L15_noncen
    s_sleep 1
    s_branch L15_nonce
L15_noncen:
    s_branch L12_lnjoin
L13_lnvar:
    s_lshr_b32 s60, s2, 4
    s_lshl_b32 s60, s60, 4
    s_cmp_lg_u32 s3, 0
    s_cbranch_scc1 L17_polln
    s_mov_b32 s6, 65535
    s_mov_b32 s7, 0
    s_mov_b64 exec, s[6:7]
    v_add_u32 v1, s60, v0
    v_lshlrev_b32 v1, 7, v1
    v_add_u32 v1, 262144, v1
    s_mov_b32 s5, 0
L17_poll:
    buffer_load_dwordx2 v[2:3], v1, s[88:91], 0 offen sc1
    s_waitcnt vmcnt(0)
    v_cmp_ne_u64 vcc, s[100:101], v[2:3]
    s_add_u32 s5, s5, 1
    s_cmp_gt_u32 s5, 0x40000
    s_cbranch_scc1 L17_pollx
    s_cbranch_vccz L17_pollx
    s_sleep 1
    s_branch L17_poll
L17_pollx:
    s_mov_b64 exec, -1
L17_polln:
    s_barrier
    s_cmp_ge_u32 s3, 8
    s_cbranch_scc1 L18_lnskip
    s_sub_u32 s84, s28, 54525952
    s_subb_u32 s85, s29, 0
    s_and_b32 s85, s85, 0xffff
    s_mov_b32 s86, 2359296
    s_mov_b32 s87, 0x00020000
    s_add_u32 s20, s28, 0
    s_addc_u32 s21, s29, 0
    s_and_b32 s21, s21, 0xffff
    s_mov_b32 s22, 2359296
    s_mov_b32 s23, 0x00020000
    s_sub_u32 s24, s28, 29360128
    s_subb_u32 s25, s29, 0
    s_and_b32 s25, s25, 0xffff
    s_mov_b32 s26, 18874368
    s_mov_b32 s27, 0x00020000
    s_add_u32 s4, s28, 58720256
    s_addc_u32 s5, s29, 0
    s_and_b32 s5, s5, 0xffff
    s_mov_b32 s6, 2359296
    s_mov_b32 s7, 0x00020000
    s_lshl_b32 s58, s2, 3
    s_add_u32 s58, s58, s3
    s_mul_i32 s64, s58, 1152
    v_lshlrev_b32 v2, 4, v0
    v_mov_b32 v8, 0
    v_mov_b32 v9, 0
    v_mov_b32 v10, 0
    v_mov_b32 v11, 0
    buffer_load_dwordx4 v[4:7], v2, s[84:87], s64 offen
    s_mul_i32 s65, s58, 2304
    v_lshlrev_b32 v3, 5, v0
    v_mov_b32 v86, 0
    v_mov_b32 v87, 0
    v_mov_b32 v88, 0
    v_mov_b32 v89, 0
    v_mov_b32 v90, 0
    v_mov_b32 v91, 0
    v_mov_b32 v92, 0
    v_mov_b32 v93, 0
    v_mov_b32 v102, 0
    v_mov_b32 v103, 0
    v_mov_b32 v104, 0
    v_mov_b32 v105, 0
    v_mov_b32 v106, 0
    v_mov_b32 v107, 0
    v_mov_b32 v108, 0
    v_mov_b32 v109, 0
    v_mov_b32 v118, 0
    v_mov_b32 v119, 0
    v_mov_b32 v120, 0
    v_mov_b32 v121, 0
    v_mov_b32 v122, 0
    v_mov_b32 v123, 0
    v_mov_b32 v124, 0
    v_mov_b32 v125, 0
    v_mov_b32 v134, 0
    v_mov_b32 v135, 0
    v_mov_b32 v136, 0
    v_mov_b32 v137, 0
    v_mov_b32 v138, 0
    v_mov_b32 v139, 0
    v_mov_b32 v140, 0
    v_mov_b32 v141, 0
    s_add_u32 s66, s65, 0
    buffer_load_dwordx4 v[78:81], v3, s[24:27], s66 offen
    buffer_load_dwordx4 v[82:85], v3, s[24:27], s66 offen offset:16
    s_add_u32 s67, s65, 4718592
    buffer_load_dwordx4 v[94:97], v3, s[24:27], s67 offen
    buffer_load_dwordx4 v[98:101], v3, s[24:27], s67 offen offset:16
    s_add_u32 s68, s65, 9437184
    buffer_load_dwordx4 v[110:113], v3, s[24:27], s68 offen
    buffer_load_dwordx4 v[114:117], v3, s[24:27], s68 offen offset:16
    s_add_u32 s69, s65, 14155776
    buffer_load_dwordx4 v[126:129], v3, s[24:27], s69 offen
    buffer_load_dwordx4 v[130:133], v3, s[24:27], s69 offen offset:16
    s_mov_b64 exec, 0xff
    buffer_load_dwordx4 v[8:11], v2, s[84:87], s64 offen offset:1024
    buffer_load_dwordx4 v[86:89], v3, s[24:27], s66 offen offset:2048
    buffer_load_dwordx4 v[90:93], v3, s[24:27], s66 offen offset:2064
    buffer_load_dwordx4 v[102:105], v3, s[24:27], s67 offen offset:2048
    buffer_load_dwordx4 v[106:109], v3, s[24:27], s67 offen offset:2064
    buffer_load_dwordx4 v[118:121], v3, s[24:27], s68 offen offset:2048
    buffer_load_dwordx4 v[122:125], v3, s[24:27], s68 offen offset:2064
    buffer_load_dwordx4 v[134:137], v3, s[24:27], s69 offen offset:2048
    buffer_load_dwordx4 v[138:141], v3, s[24:27], s69 offen offset:2064
    s_mov_b64 exec, -1
    s_waitcnt vmcnt(0)
    v_lshlrev_b32 v16, 16, v4
    v_and_b32 v17, 0xffff0000, v4
    v_lshlrev_b32 v18, 16, v5
    v_and_b32 v19, 0xffff0000, v5
    v_lshlrev_b32 v20, 16, v6
    v_and_b32 v21, 0xffff0000, v6
    v_lshlrev_b32 v22, 16, v7
    v_and_b32 v23, 0xffff0000, v7
    v_lshlrev_b32 v24, 16, v8
    v_and_b32 v25, 0xffff0000, v8
    v_lshlrev_b32 v26, 16, v9
    v_and_b32 v27, 0xffff0000, v9
    v_lshlrev_b32 v28, 16, v10
    v_and_b32 v29, 0xffff0000, v10
    v_lshlrev_b32 v30, 16, v11
    v_and_b32 v31, 0xffff0000, v11
    v_add_f32 v78, v78, v94
    v_add_f32 v78, v78, v110
    v_add_f32 v78, v78, v126
    v_add_f32 v79, v79, v95
    v_add_f32 v79, v79, v111
    v_add_f32 v79, v79, v127
    v_add_f32 v80, v80, v96
    v_add_f32 v80, v80, v112
    v_add_f32 v80, v80, v128
    v_add_f32 v81, v81, v97
    v_add_f32 v81, v81, v113
    v_add_f32 v81, v81, v129
    v_add_f32 v82, v82, v98
    v_add_f32 v82, v82, v114
    v_add_f32 v82, v82, v130
    v_add_f32 v83, v83, v99
    v_add_f32 v83, v83, v115
    v_add_f32 v83, v83, v131
    v_add_f32 v84, v84, v100
    v_add_f32 v84, v84, v116
    v_add_f32 v84, v84, v132
    v_add_f32 v85, v85, v101
    v_add_f32 v85, v85, v117
    v_add_f32 v85, v85, v133
    v_add_f32 v86, v86, v102
    v_add_f32 v86, v86, v118
    v_add_f32 v86, v86, v134
    v_add_f32 v87, v87, v103
    v_add_f32 v87, v87, v119
    v_add_f32 v87, v87, v135
    v_add_f32 v88, v88, v104
    v_add_f32 v88, v88, v120
    v_add_f32 v88, v88, v136
    v_add_f32 v89, v89, v105
    v_add_f32 v89, v89, v121
    v_add_f32 v89, v89, v137
    v_add_f32 v90, v90, v106
    v_add_f32 v90, v90, v122
    v_add_f32 v90, v90, v138
    v_add_f32 v91, v91, v107
    v_add_f32 v91, v91, v123
    v_add_f32 v91, v91, v139
    v_add_f32 v92, v92, v108
    v_add_f32 v92, v92, v124
    v_add_f32 v92, v92, v140
    v_add_f32 v93, v93, v109
    v_add_f32 v93, v93, v125
    v_add_f32 v93, v93, v141
    v_cvt_pk_bf16_f32 v4, v78, v79
    v_cvt_pk_bf16_f32 v5, v80, v81
    v_cvt_pk_bf16_f32 v6, v82, v83
    v_cvt_pk_bf16_f32 v7, v84, v85
    v_cvt_pk_bf16_f32 v8, v86, v87
    v_cvt_pk_bf16_f32 v9, v88, v89
    v_cvt_pk_bf16_f32 v10, v90, v91
    v_cvt_pk_bf16_f32 v11, v92, v93
    v_lshlrev_b32 v78, 16, v4
    v_and_b32 v79, 0xffff0000, v4
    v_lshlrev_b32 v80, 16, v5
    v_and_b32 v81, 0xffff0000, v5
    v_lshlrev_b32 v82, 16, v6
    v_and_b32 v83, 0xffff0000, v6
    v_lshlrev_b32 v84, 16, v7
    v_and_b32 v85, 0xffff0000, v7
    v_lshlrev_b32 v86, 16, v8
    v_and_b32 v87, 0xffff0000, v8
    v_lshlrev_b32 v88, 16, v9
    v_and_b32 v89, 0xffff0000, v9
    v_lshlrev_b32 v90, 16, v10
    v_and_b32 v91, 0xffff0000, v10
    v_lshlrev_b32 v92, 16, v11
    v_and_b32 v93, 0xffff0000, v11
    v_add_f32 v16, v16, v78
    v_add_f32 v17, v17, v79
    v_add_f32 v18, v18, v80
    v_add_f32 v19, v19, v81
    v_add_f32 v20, v20, v82
    v_add_f32 v21, v21, v83
    v_add_f32 v22, v22, v84
    v_add_f32 v23, v23, v85
    v_add_f32 v24, v24, v86
    v_add_f32 v25, v25, v87
    v_add_f32 v26, v26, v88
    v_add_f32 v27, v27, v89
    v_add_f32 v28, v28, v90
    v_add_f32 v29, v29, v91
    v_add_f32 v30, v30, v92
    v_add_f32 v31, v31, v93
    v_cvt_pk_bf16_f32 v4, v16, v17
    v_cvt_pk_bf16_f32 v5, v18, v19
    v_cvt_pk_bf16_f32 v6, v20, v21
    v_cvt_pk_bf16_f32 v7, v22, v23
    v_cvt_pk_bf16_f32 v8, v24, v25
    v_cvt_pk_bf16_f32 v9, v26, v27
    v_cvt_pk_bf16_f32 v10, v28, v29
    v_cvt_pk_bf16_f32 v11, v30, v31
    v_lshlrev_b32 v16, 16, v4
    v_and_b32 v17, 0xffff0000, v4
    v_lshlrev_b32 v18, 16, v5
    v_and_b32 v19, 0xffff0000, v5
    v_lshlrev_b32 v20, 16, v6
    v_and_b32 v21, 0xffff0000, v6
    v_lshlrev_b32 v22, 16, v7
    v_and_b32 v23, 0xffff0000, v7
    v_lshlrev_b32 v24, 16, v8
    v_and_b32 v25, 0xffff0000, v8
    v_lshlrev_b32 v26, 16, v9
    v_and_b32 v27, 0xffff0000, v9
    v_lshlrev_b32 v28, 16, v10
    v_and_b32 v29, 0xffff0000, v10
    v_lshlrev_b32 v30, 16, v11
    v_and_b32 v31, 0xffff0000, v11
    buffer_store_dwordx4 v[4:7], v2, s[4:7], s64 offen sc1
    s_mov_b64 exec, 0xff
    buffer_store_dwordx4 v[8:11], v2, s[4:7], s64 offen offset:1024 sc1
    s_mov_b64 exec, -1
    v_add_f32 v94, v16, v17
    v_add_f32 v94, v94, v18
    v_add_f32 v94, v94, v19
    v_add_f32 v94, v94, v20
    v_add_f32 v94, v94, v21
    v_add_f32 v94, v94, v22
    v_add_f32 v94, v94, v23
    v_add_f32 v94, v94, v24
    v_add_f32 v94, v94, v25
    v_add_f32 v94, v94, v26
    v_add_f32 v94, v94, v27
    v_add_f32 v94, v94, v28
    v_add_f32 v94, v94, v29
    v_add_f32 v94, v94, v30
    v_add_f32 v94, v94, v31
    s_nop 1
    v_add_f32_dpp v94, v94, v94 row_shr:1 row_mask:0xf bank_mask:0xf
    s_nop 1
    v_add_f32_dpp v94, v94, v94 row_shr:2 row_mask:0xf bank_mask:0xf
    s_nop 1
    v_add_f32_dpp v94, v94, v94 row_shr:4 row_mask:0xf bank_mask:0xf
    s_nop 1
    v_add_f32_dpp v94, v94, v94 row_shr:8 row_mask:0xf bank_mask:0xf
    s_nop 1
    v_add_f32_dpp v94, v94, v94 row_bcast:15 row_mask:0xa bank_mask:0xf
    s_nop 1
    v_add_f32_dpp v94, v94, v94 row_bcast:31 row_mask:0xc bank_mask:0xf
    s_nop 0
    v_readlane_b32 s70, v94, 63
    s_mov_b32 s71, 0x3ae38e39
    s_nop 0
    v_mov_b32 v95, s70
    v_mul_f32 v95, s71, v95
    v_mov_b32 v96, 0
    v_mov_b32 v97, 0
    v_sub_f32 v98, v16, v95
    v_fmac_f32 v96, v98, v98
    v_sub_f32 v98, v17, v95
    v_fmac_f32 v96, v98, v98
    v_sub_f32 v98, v18, v95
    v_fmac_f32 v96, v98, v98
    v_sub_f32 v98, v19, v95
    v_fmac_f32 v96, v98, v98
    v_sub_f32 v98, v20, v95
    v_fmac_f32 v96, v98, v98
    v_sub_f32 v98, v21, v95
    v_fmac_f32 v96, v98, v98
    v_sub_f32 v98, v22, v95
    v_fmac_f32 v96, v98, v98
    v_sub_f32 v98, v23, v95
    v_fmac_f32 v96, v98, v98
    s_mov_b64 exec, 0xff
    v_sub_f32 v98, v24, v95
    v_fmac_f32 v97, v98, v98
    v_sub_f32 v98, v25, v95
    v_fmac_f32 v97, v98, v98
    v_sub_f32 v98, v26, v95
    v_fmac_f32 v97, v98, v98
    v_sub_f32 v98, v27, v95
    v_fmac_f32 v97, v98, v98
    v_sub_f32 v98, v28, v95
    v_fmac_f32 v97, v98, v98
    v_sub_f32 v98, v29, v95
    v_fmac_f32 v97, v98, v98
    v_sub_f32 v98, v30, v95
    v_fmac_f32 v97, v98, v98
    v_sub_f32 v98, v31, v95
    v_fmac_f32 v97, v98, v98
    s_mov_b64 exec, -1
    v_add_f32 v96, v96, v97
    s_nop 1
    v_add_f32_dpp v96, v96, v96 row_shr:1 row_mask:0xf bank_mask:0xf
    s_nop 1
    v_add_f32_dpp v96, v96, v96 row_shr:2 row_mask:0xf bank_mask:0xf
    s_nop 1
    v_add_f32_dpp v96, v96, v96 row_shr:4 row_mask:0xf bank_mask:0xf
    s_nop 1
    v_add_f32_dpp v96, v96, v96 row_shr:8 row_mask:0xf bank_mask:0xf
    s_nop 1
    v_add_f32_dpp v96, v96, v96 row_bcast:15 row_mask:0xa bank_mask:0xf
    s_nop 1
    v_add_f32_dpp v96, v96, v96 row_bcast:31 row_mask:0xc bank_mask:0xf
    s_nop 0
    v_readlane_b32 s70, v96, 63
    s_nop 1
    v_mov_b32 v97, s70
    v_mul_f32 v97, s71, v97
    v_cvt_pk_bf16_f32 v98, v95, v97
    v_lshlrev_b32 v95, 16, v98
    v_and_b32 v97, 0xffff0000, v98
    v_add_f32 v97, 0x3727c5ac, v97
    v_cvt_pk_bf16_f32 v98, v97, v97
    v_lshlrev_b32 v97, 16, v98
    v_sqrt_f32 v97, v97
    s_nop 0
    v_cvt_pk_bf16_f32 v98, v97, v97
    v_lshlrev_b32 v97, 16, v98
    v_rcp_f32 v97, v97
    v_sub_f32 v16, v16, v95
    v_sub_f32 v17, v17, v95
    v_sub_f32 v18, v18, v95
    v_sub_f32 v19, v19, v95
    v_sub_f32 v20, v20, v95
    v_sub_f32 v21, v21, v95
    v_sub_f32 v22, v22, v95
    v_sub_f32 v23, v23, v95
    v_sub_f32 v24, v24, v95
    v_sub_f32 v25, v25, v95
    v_sub_f32 v26, v26, v95
    v_sub_f32 v27, v27, v95
    v_sub_f32 v28, v28, v95
    v_sub_f32 v29, v29, v95
    v_sub_f32 v30, v30, v95
    v_sub_f32 v31, v31, v95
    v_cvt_pk_bf16_f32 v102, v16, v17
    v_cvt_pk_bf16_f32 v103, v18, v19
    v_cvt_pk_bf16_f32 v104, v20, v21
    v_cvt_pk_bf16_f32 v105, v22, v23
    v_cvt_pk_bf16_f32 v106, v24, v25
    v_cvt_pk_bf16_f32 v107, v26, v27
    v_cvt_pk_bf16_f32 v108, v28, v29
    v_cvt_pk_bf16_f32 v109, v30, v31
    v_lshlrev_b32 v16, 16, v102
    v_and_b32 v17, 0xffff0000, v102
    v_lshlrev_b32 v18, 16, v103
    v_and_b32 v19, 0xffff0000, v103
    v_lshlrev_b32 v20, 16, v104
    v_and_b32 v21, 0xffff0000, v104
    v_lshlrev_b32 v22, 16, v105
    v_and_b32 v23, 0xffff0000, v105
    v_lshlrev_b32 v24, 16, v106
    v_and_b32 v25, 0xffff0000, v106
    v_lshlrev_b32 v26, 16, v107
    v_and_b32 v27, 0xffff0000, v107
    v_lshlrev_b32 v28, 16, v108
    v_and_b32 v29, 0xffff0000, v108
    v_lshlrev_b32 v30, 16, v109
    v_and_b32 v31, 0xffff0000, v109
    v_mul_f32 v16, v16, v97
    v_mul_f32 v17, v17, v97
    v_mul_f32 v18, v18, v97
    v_mul_f32 v19, v19, v97
    v_mul_f32 v20, v20, v97
    v_mul_f32 v21, v21, v97
    v_mul_f32 v22, v22, v97
    v_mul_f32 v23, v23, v97
    v_mul_f32 v24, v24, v97
    v_mul_f32 v25, v25, v97
    v_mul_f32 v26, v26, v97
    v_mul_f32 v27, v27, v97
    v_mul_f32 v28, v28, v97
    v_mul_f32 v29, v29, v97
    v_mul_f32 v30, v30, v97
    v_mul_f32 v31, v31, v97
    v_cvt_pk_bf16_f32 v102, v16, v17
    v_cvt_pk_bf16_f32 v103, v18, v19
    v_cvt_pk_bf16_f32 v104, v20, v21
    v_cvt_pk_bf16_f32 v105, v22, v23
    v_cvt_pk_bf16_f32 v106, v24, v25
    v_cvt_pk_bf16_f32 v107, v26, v27
    v_cvt_pk_bf16_f32 v108, v28, v29
    v_cvt_pk_bf16_f32 v109, v30, v31
    buffer_store_dwordx4 v[102:105], v2, s[20:23], s64 offen sc1
    s_mov_b64 exec, 0xff
    buffer_store_dwordx4 v[106:109], v2, s[20:23], s64 offen offset:1024 sc1
    s_mov_b64 exec, -1
L18_lnskip:
L12_lnjoin:
    s_waitcnt vmcnt(0)
    s_barrier
    s_cmp_lg_u32 s3, 0
    s_cbranch_scc1 L19_pub
    s_lshl_b32 s4, s2, 7
    s_add_u32 s4, s4, 327680
    s_add_u32 s4, s4, s99
    v_mov_b32 v1, s4
    v_mov_b32 v2, s100
    v_mov_b32 v3, s101
    s_mov_b64 exec, 1
    buffer_store_dwordx2 v[2:3], v1, s[88:91], 0 offen sc1
    s_mov_b64 exec, -1
L19_pub:
    s_load_dwordx2 s[64:65], s[0:1], 8
    s_and_b32 s68, s2, 7
    s_lshr_b32 s69, s2, 3
    s_lshr_b32 s70, s68, 1
    s_lshl_b32 s70, s70, 2
    s_and_b32 s71, s69, 3
    s_add_u32 s70, s70, s71
    s_and_b32 s68, s68, 1
    s_lshl_b32 s68, s68, 3
    s_lshr_b32 s69, s69, 2
    s_add_u32 s69, s69, s68
    s_mov_b32 s68, s70
    s_mul_i32 s61, s68, 147456
    s_sub_u32 s61, s61, 18432
    s_waitcnt lgkmcnt(0)
    s_add_u32 s8, s28, 0
    s_addc_u32 s9, s29, 0
    s_and_b32 s9, s9, 0xffff
    s_mov_b32 s10, 2359296
    s_mov_b32 s11, 0x00020000
    s_mul_i32 s6, s69, 72
    s_add_u32 s12, s64, s6
    s_addc_u32 s13, s65, 0
    s_and_b32 s13, s13, 0xffff
    s_mov_b32 s14, 0
    s_mov_b32 s15, 0x00020000
    s_sub_u32 s14, 1990656, s6
    s_mov_b32 s16, s12
    s_mov_b32 s17, s13
    s_mov_b32 s18, s14
    s_mov_b32 s19, s15
    s_add_u32 s20, s28, 8388608
    s_addc_u32 s21, s29, 0
    s_and_b32 s21, s21, 0xffff
    s_mov_b32 s22, 2359296
    s_mov_b32 s23, 0x00020000
    s_cmp_lg_u32 s3, 0
    s_cbranch_scc1 L20_polln
    s_mov_b32 s6, -1
    s_mov_b32 s7, 0
    s_mov_b64 exec, s[6:7]
    v_add_u32 v1, s59, v0
    v_lshlrev_b32 v1, 7, v1
    v_add_u32 v1, 327680, v1
    v_add_u32 v1, s99, v1
    s_mov_b32 s5, 0
L20_poll:
    buffer_load_dwordx2 v[2:3], v1, s[88:91], 0 offen sc1
    s_waitcnt vmcnt(0)
    v_cmp_ne_u64 vcc, s[100:101], v[2:3]
    s_add_u32 s5, s5, 1
    s_cmp_gt_u32 s5, 0x40000
    s_cbranch_scc1 L20_pollx
    s_cbranch_vccz L20_pollx
    s_sleep 1
    s_branch L20_poll
L20_pollx:
    s_mov_b64 exec, -1
L20_polln:
    s_barrier
    s_cmp_ge_u32 s3, 18
    s_cbranch_scc1 L21_ta
    s_add_u32 m0, s56, 0
    s_nop 0
    buffer_load_dwordx4 v74, s[32:35], s72 offen lds
    s_add_u32 s72, s72, s78
L21_ta:
    s_cmp_ge_u32 s3, 6
    s_cbranch_scc1 L22_ta
    s_add_u32 m0, s56, 12288
    s_nop 0
    buffer_load_dwordx4 v75, s[36:39], s73 offen lds
    s_add_u32 s73, s73, s79
L22_ta:
    s_cmp_ge_u32 s3, 18
    s_cbranch_scc1 L23_ta
    s_add_u32 m0, s56, 34816
    s_nop 0
    buffer_load_dwordx4 v74, s[32:35], s72 offen lds
    s_add_u32 s72, s72, s78
L23_ta:
    s_cmp_ge_u32 s3, 6
    s_cbranch_scc1 L24_ta
    s_add_u32 m0, s56, 47104
    s_nop 0
    buffer_load_dwordx4 v75, s[36:39], s73 offen lds
    s_add_u32 s73, s73, s79
L24_ta:
    s_cmp_ge_u32 s3, 18
    s_cbranch_scc1 L25_ta
    s_add_u32 m0, s56, 69632
    s_nop 0
    buffer_load_dwordx4 v74, s[32:35], s72 offen lds
    s_add_u32 s72, s72, s78
L25_ta:
    s_cmp_ge_u32 s3, 6
    s_cbranch_scc1 L26_ta
    s_add_u32 m0, s56, 81920
    s_nop 0
    buffer_load_dwordx4 v75, s[36:39], s73 offen lds
    s_add_u32 s73, s73, s79
L26_ta:
    s_cmp_ge_u32 s3, 18
    s_cbranch_scc1 L27_ta
    s_add_u32 m0, s56, 104448
    s_nop 0
    buffer_load_dwordx4 v74, s[32:35], s72 offen lds
    s_add_u32 s72, s72, s78
L27_ta:
    s_cmp_ge_u32 s3, 6
    s_cbranch_scc1 L28_ta
    s_add_u32 m0, s56, 116736
    s_nop 0
    buffer_load_dwordx4 v75, s[36:39], s73 offen lds
    s_add_u32 s73, s73, s79
L28_ta:
    s_cmp_ge_u32 s3, 6
    s_cbranch_scc1 L29_awa
    s_waitcnt vmcnt(6)
    s_branch L29_awb
L29_awa:
    s_waitcnt vmcnt(3)
L29_awb:
    s_barrier
    ds_read_b128 v[26:29], v58 offset:0
    ds_read_b128 v[30:33], v58 offset:2048
    ds_read_b128 v[34:37], v58 offset:4096
    ds_read_b64_tr_b16 v[50:51], v66 offset:0
    ds_read_b64_tr_b16 v[52:53], v66 offset:2048
    ds_read_b64_tr_b16 v[54:55], v67 offset:0
    ds_read_b64_tr_b16 v[56:57], v67 offset:2048
    ds_read_b128 v[38:41], v59 offset:0
    ds_read_b128 v[42:45], v59 offset:2048
    ds_read_b128 v[46:49], v59 offset:4096
    s_waitcnt lgkmcnt(5)
    v_mfma_f32_16x16x32_bf16 v[2:5], v[50:53], v[26:29], 0
    v_mfma_f32_16x16x32_bf16 v[6:9], v[50:53], v[30:33], 0
    v_mfma_f32_16x16x32_bf16 v[10:13], v[50:53], v[34:37], 0
    ds_read_b64_tr_b16 v[50:51], v66 offset:8192
    ds_read_b64_tr_b16 v[52:53], v66 offset:10240
    s_waitcnt lgkmcnt(5)
    v_mfma_f32_16x16x32_bf16 v[14:17], v[54:57], v[26:29], 0
    v_mfma_f32_16x16x32_bf16 v[18:21], v[54:57], v[30:33], 0
    v_mfma_f32_16x16x32_bf16 v[22:25], v[54:57], v[34:37], 0
    ds_read_b64_tr_b16 v[54:55], v67 offset:8192
    ds_read_b64_tr_b16 v[56:57], v67 offset:10240
    s_waitcnt lgkmcnt(0)
    s_waitcnt vmcnt(0)
    s_barrier
    s_cmp_lt_u32 s3, 8
    s_cbranch_scc1 L31_nowarm
    s_cmp_lg_u32 s99, 0
    s_cbranch_scc1 L31_nowarm
    s_load_dwordx2 s[4:5], s[0:1], 16
    s_load_dwordx4 s[84:87], s[0:1], 32
    s_load_dwordx2 s[6:7], s[0:1], 48
    s_lshl_b32 s24, s2, 2
    s_add_u32 s24, s24, s3
    s_sub_u32 s24, s24, 8
    s_lshl_b32 s24, s24, 6
    v_add_u32 v160, s24, v0
    v_lshlrev_b32 v160, 7, v160
    s_waitcnt lgkmcnt(0)
    s_mov_b32 s24, s4
    s_and_b32 s25, s5, 0xffff
    s_mov_b32 s26, 663552
    s_mov_b32 s27, 0x00020000
    buffer_load_dword v156, v160, s[24:27], 0 offen
    s_mov_b32 s24, s84
    s_and_b32 s25, s85, 0xffff
    s_mov_b32 s26, 5308416
    s_mov_b32 s27, 0x00020000
    buffer_load_dword v157, v160, s[24:27], 0 offen
    s_mov_b32 s24, s86
    s_and_b32 s25, s87, 0xffff
    s_mov_b32 s26, 5308416
    s_mov_b32 s27, 0x00020000
    buffer_load_dword v158, v160, s[24:27], 0 offen
    s_mov_b32 s24, s6
    s_and_b32 s25, s7, 0xffff
    s_mov_b32 s26, 5308416
    s_mov_b32 s27, 0x00020000
    buffer_load_dword v159, v160, s[24:27], 0 offen
L31_nowarm:
    ds_read_b128 v[26:29], v60 offset:0
    ds_read_b128 v[30:33], v60 offset:2048
    ds_read_b128 v[34:37], v60 offset:4096
    s_waitcnt lgkmcnt(5)
    v_mfma_f32_16x16x32_bf16 v[2:5], v[50:53], v[38:41], v[2:5]
    v_mfma_f32_16x16x32_bf16 v[6:9], v[50:53], v[42:45], v[6:9]
    v_mfma_f32_16x16x32_bf16 v[10:13], v[50:53], v[46:49], v[10:13]
    ds_read_b64_tr_b16 v[50:51], v68 offset:0
    ds_read_b64_tr_b16 v[52:53], v68 offset:2048
    s_add_u32 m0, s56, 0
    s_nop 0
    buffer_load_dwordx4 v74, s[32:35], s72 offen lds
    s_add_u32 s72, s72, s78
    s_waitcnt lgkmcnt(5)
    v_mfma_f32_16x16x32_bf16 v[14:17], v[54:57], v[38:41], v[14:17]
    v_mfma_f32_16x16x32_bf16 v[18:21], v[54:57], v[42:45], v[18:21]
    v_mfma_f32_16x16x32_bf16 v[22:25], v[54:57], v[46:49], v[22:25]
    ds_read_b64_tr_b16 v[54:55], v69 offset:0
    ds_read_b64_tr_b16 v[56:57], v69 offset:2048
    s_add_u32 m0, s56, 12288
    s_nop 0
    buffer_load_dwordx4 v75, s[36:39], s73 offen lds
    s_add_u32 s73, s73, s79
    s_cmp_eq_u32 s57, 1
    s_cbranch_scc1 L32_d
    s_add_u32 m0, s56, 24576
    s_nop 0
    buffer_load_dwordx4 v76, s[40:43], s74 offen lds
    s_add_u32 s74, s74, s80
L32_d:
    ds_read_b128 v[38:41], v61 offset:0
    ds_read_b128 v[42:45], v61 offset:2048
    ds_read_b128 v[46:49], v61 offset:4096
    s_waitcnt lgkmcnt(5)
    v_mfma_f32_16x16x32_bf16 v[2:5], v[50:53], v[26:29], v[2:5]
    v_mfma_f32_16x16x32_bf16 v[6:9], v[50:53], v[30:33], v[6:9]
    v_mfma_f32_16x16x32_bf16 v[10:13], v[50:53], v[34:37], v[10:13]
    ds_read_b64_tr_b16 v[50:51], v68 offset:8192
    ds_read_b64_tr_b16 v[52:53], v68 offset:10240
    s_waitcnt lgkmcnt(5)
    v_mfma_f32_16x16x32_bf16 v[14:17], v[54:57], v[26:29], v[14:17]
    v_mfma_f32_16x16x32_bf16 v[18:21], v[54:57], v[30:33], v[18:21]
    v_mfma_f32_16x16x32_bf16 v[22:25], v[54:57], v[34:37], v[22:25]
    ds_read_b64_tr_b16 v[54:55], v69 offset:8192
    ds_read_b64_tr_b16 v[56:57], v69 offset:10240
    s_waitcnt lgkmcnt(0)
    s_barrier
    ds_read_b128 v[26:29], v62 offset:0
    ds_read_b128 v[30:33], v62 offset:2048
    ds_read_b128 v[34:37], v62 offset:4096
    s_waitcnt lgkmcnt(5)
    v_mfma_f32_16x16x32_bf16 v[2:5], v[50:53], v[38:41], v[2:5]
    v_mfma_f32_16x16x32_bf16 v[6:9], v[50:53], v[42:45], v[6:9]
    v_mfma_f32_16x16x32_bf16 v[10:13], v[50:53], v[46:49], v[10:13]
    ds_read_b64_tr_b16 v[50:51], v70 offset:0
    ds_read_b64_tr_b16 v[52:53], v70 offset:2048
    s_add_u32 m0, s56, 34816
    s_nop 0
    buffer_load_dwordx4 v74, s[32:35], s72 offen lds
    s_add_u32 s72, s72, s78
    s_waitcnt lgkmcnt(5)
    v_mfma_f32_16x16x32_bf16 v[14:17], v[54:57], v[38:41], v[14:17]
    v_mfma_f32_16x16x32_bf16 v[18:21], v[54:57], v[42:45], v[18:21]
    v_mfma_f32_16x16x32_bf16 v[22:25], v[54:57], v[46:49], v[22:25]
    ds_read_b64_tr_b16 v[54:55], v71 offset:0
    ds_read_b64_tr_b16 v[56:57], v71 offset:2048
    s_add_u32 m0, s56, 47104
    s_nop 0
    buffer_load_dwordx4 v75, s[36:39], s73 offen lds
    s_add_u32 s73, s73, s79
    s_cmp_eq_u32 s57, 1
    s_cbranch_scc1 L33_d
    s_add_u32 m0, s56, 59392
    s_nop 0
    buffer_load_dwordx4 v76, s[40:43], s74 offen lds
    s_add_u32 s74, s74, s80
L33_d:
    ds_read_b128 v[38:41], v63 offset:0
    ds_read_b128 v[42:45], v63 offset:2048
    ds_read_b128 v[46:49], v63 offset:4096
    s_waitcnt lgkmcnt(5)
    v_mfma_f32_16x16x32_bf16 v[2:5], v[50:53], v[26:29], v[2:5]
    v_mfma_f32_16x16x32_bf16 v[6:9], v[50:53], v[30:33], v[6:9]
    v_mfma_f32_16x16x32_bf16 v[10:13], v[50:53], v[34:37], v[10:13]
    ds_read_b64_tr_b16 v[50:51], v70 offset:8192
    ds_read_b64_tr_b16 v[52:53], v70 offset:10240
    s_waitcnt lgkmcnt(5)
    v_mfma_f32_16x16x32_bf16 v[14:17], v[54:57], v[26:29], v[14:17]
    v_mfma_f32_16x16x32_bf16 v[18:21], v[54:57], v[30:33], v[18:21]
    v_mfma_f32_16x16x32_bf16 v[22:25], v[54:57], v[34:37], v[22:25]
    ds_read_b64_tr_b16 v[54:55], v71 offset:8192
    ds_read_b64_tr_b16 v[56:57], v71 offset:10240
    s_waitcnt lgkmcnt(0)
    s_barrier
    ds_read_b128 v[26:29], v64 offset:0
    ds_read_b128 v[30:33], v64 offset:2048
    ds_read_b128 v[34:37], v64 offset:4096
    s_waitcnt lgkmcnt(5)
    v_mfma_f32_16x16x32_bf16 v[2:5], v[50:53], v[38:41], v[2:5]
    v_mfma_f32_16x16x32_bf16 v[6:9], v[50:53], v[42:45], v[6:9]
    v_mfma_f32_16x16x32_bf16 v[10:13], v[50:53], v[46:49], v[10:13]
    ds_read_b64_tr_b16 v[50:51], v72 offset:0
    ds_read_b64_tr_b16 v[52:53], v72 offset:2048
    s_add_u32 m0, s56, 69632
    s_nop 0
    buffer_load_dwordx4 v74, s[32:35], s72 offen lds
    s_add_u32 s72, s72, s78
    s_waitcnt lgkmcnt(5)
    v_mfma_f32_16x16x32_bf16 v[14:17], v[54:57], v[38:41], v[14:17]
    v_mfma_f32_16x16x32_bf16 v[18:21], v[54:57], v[42:45], v[18:21]
    v_mfma_f32_16x16x32_bf16 v[22:25], v[54:57], v[46:49], v[22:25]
    ds_read_b64_tr_b16 v[54:55], v73 offset:0
    ds_read_b64_tr_b16 v[56:57], v73 offset:2048
    s_add_u32 m0, s56, 81920
    s_nop 0
    buffer_load_dwordx4 v75, s[36:39], s73 offen lds
    s_add_u32 s73, s73, s79
    s_cmp_eq_u32 s57, 1
    s_cbranch_scc1 L34_d
    s_add_u32 m0, s56, 94208
    s_nop 0
    buffer_load_dwordx4 v76, s[40:43], s74 offen lds
    s_add_u32 s74, s74, s80
L34_d:
    ds_read_b128 v[38:41], v65 offset:0
    ds_read_b128 v[42:45], v65 offset:2048
    ds_read_b128 v[46:49], v65 offset:4096
    s_waitcnt lgkmcnt(5)
    v_mfma_f32_16x16x32_bf16 v[2:5], v[50:53], v[26:29], v[2:5]
    v_mfma_f32_16x16x32_bf16 v[6:9], v[50:53], v[30:33], v[6:9]
    v_mfma_f32_16x16x32_bf16 v[10:13], v[50:53], v[34:37], v[10:13]
    ds_read_b64_tr_b16 v[50:51], v72 offset:8192
    ds_read_b64_tr_b16 v[52:53], v72 offset:10240
    s_waitcnt lgkmcnt(5)
    v_mfma_f32_16x16x32_bf16 v[14:17], v[54:57], v[26:29], v[14:17]
    v_mfma_f32_16x16x32_bf16 v[18:21], v[54:57], v[30:33], v[18:21]
    v_mfma_f32_16x16x32_bf16 v[22:25], v[54:57], v[34:37], v[22:25]
    ds_read_b64_tr_b16 v[54:55], v73 offset:8192
    ds_read_b64_tr_b16 v[56:57], v73 offset:10240
    s_waitcnt lgkmcnt(0)
    s_cmp_eq_u32 s57, 1
    s_cbranch_scc1 L35_wa
    s_waitcnt vmcnt(6)
    s_branch L35_wb
L35_wa:
    s_waitcnt vmcnt(4)
L35_wb:
    s_barrier
    ds_read_b128 v[26:29], v58 offset:0
    ds_read_b128 v[30:33], v58 offset:2048
    ds_read_b128 v[34:37], v58 offset:4096
    s_waitcnt lgkmcnt(5)
    v_mfma_f32_16x16x32_bf16 v[2:5], v[50:53], v[38:41], v[2:5]
    v_mfma_f32_16x16x32_bf16 v[6:9], v[50:53], v[42:45], v[6:9]
    v_mfma_f32_16x16x32_bf16 v[10:13], v[50:53], v[46:49], v[10:13]
    ds_read_b64_tr_b16 v[50:51], v66 offset:0
    ds_read_b64_tr_b16 v[52:53], v66 offset:2048
    s_add_u32 m0, s56, 104448
    s_nop 0
    buffer_load_dwordx4 v74, s[32:35], s72 offen lds
    s_add_u32 s72, s72, s78
    s_waitcnt lgkmcnt(5)
    v_mfma_f32_16x16x32_bf16 v[14:17], v[54:57], v[38:41], v[14:17]
    v_mfma_f32_16x16x32_bf16 v[18:21], v[54:57], v[42:45], v[18:21]
    v_mfma_f32_16x16x32_bf16 v[22:25], v[54:57], v[46:49], v[22:25]
    ds_read_b64_tr_b16 v[54:55], v67 offset:0
    ds_read_b64_tr_b16 v[56:57], v67 offset:2048
    s_add_u32 m0, s56, 116736
    s_nop 0
    buffer_load_dwordx4 v75, s[36:39], s73 offen lds
    s_add_u32 s73, s73, s79
    s_cmp_eq_u32 s57, 1
    s_cbranch_scc1 L36_d
    s_add_u32 m0, s56, 129024
    s_nop 0
    buffer_load_dwordx4 v76, s[40:43], s74 offen lds
    s_add_u32 s74, s74, s80
L36_d:
    ds_read_b128 v[38:41], v59 offset:0
    ds_read_b128 v[42:45], v59 offset:2048
    ds_read_b128 v[46:49], v59 offset:4096
    s_waitcnt lgkmcnt(5)
    v_mfma_f32_16x16x32_bf16 v[2:5], v[50:53], v[26:29], v[2:5]
    v_mfma_f32_16x16x32_bf16 v[6:9], v[50:53], v[30:33], v[6:9]
    v_mfma_f32_16x16x32_bf16 v[10:13], v[50:53], v[34:37], v[10:13]
    ds_read_b64_tr_b16 v[50:51], v66 offset:8192
    ds_read_b64_tr_b16 v[52:53], v66 offset:10240
    s_waitcnt lgkmcnt(5)
    v_mfma_f32_16x16x32_bf16 v[14:17], v[54:57], v[26:29], v[14:17]
    v_mfma_f32_16x16x32_bf16 v[18:21], v[54:57], v[30:33], v[18:21]
    v_mfma_f32_16x16x32_bf16 v[22:25], v[54:57], v[34:37], v[22:25]
    ds_read_b64_tr_b16 v[54:55], v67 offset:8192
    ds_read_b64_tr_b16 v[56:57], v67 offset:10240
    s_waitcnt lgkmcnt(0)
    s_cmp_eq_u32 s57, 1
    s_cbranch_scc1 L37_wa
    s_waitcnt vmcnt(6)
    s_branch L37_wb
L37_wa:
    s_waitcnt vmcnt(4)
L37_wb:
    s_barrier
    ds_read_b128 v[26:29], v60 offset:0
    ds_read_b128 v[30:33], v60 offset:2048
    ds_read_b128 v[34:37], v60 offset:4096
    s_waitcnt lgkmcnt(5)
    v_mfma_f32_16x16x32_bf16 v[2:5], v[50:53], v[38:41], v[2:5]
    v_mfma_f32_16x16x32_bf16 v[6:9], v[50:53], v[42:45], v[6:9]
    v_mfma_f32_16x16x32_bf16 v[10:13], v[50:53], v[46:49], v[10:13]
    ds_read_b64_tr_b16 v[50:51], v68 offset:0
    ds_read_b64_tr_b16 v[52:53], v68 offset:2048
    s_add_u32 m0, s56, 0
    s_nop 0
    buffer_load_dwordx4 v74, s[32:35], s72 offen lds
    s_add_u32 s72, s72, s78
    s_waitcnt lgkmcnt(5)
    v_mfma_f32_16x16x32_bf16 v[14:17], v[54:57], v[38:41], v[14:17]
    v_mfma_f32_16x16x32_bf16 v[18:21], v[54:57], v[42:45], v[18:21]
    v_mfma_f32_16x16x32_bf16 v[22:25], v[54:57], v[46:49], v[22:25]
    ds_read_b64_tr_b16 v[54:55], v69 offset:0
    ds_read_b64_tr_b16 v[56:57], v69 offset:2048
    s_add_u32 m0, s56, 12288
    s_nop 0
    buffer_load_dwordx4 v75, s[36:39], s73 offen lds
    s_add_u32 s73, s73, s79
    s_cmp_eq_u32 s57, 1
    s_cbranch_scc1 L38_d
    s_add_u32 m0, s56, 24576
    s_nop 0
    buffer_load_dwordx4 v76, s[40:43], s74 offen lds
    s_add_u32 s74, s74, s80
L38_d:
    ds_read_b128 v[38:41], v61 offset:0
    ds_read_b128 v[42:45], v61 offset:2048
    ds_read_b128 v[46:49], v61 offset:4096
    s_waitcnt lgkmcnt(5)
    v_mfma_f32_16x16x32_bf16 v[2:5], v[50:53], v[26:29], v[2:5]
    v_mfma_f32_16x16x32_bf16 v[6:9], v[50:53], v[30:33], v[6:9]
    v_mfma_f32_16x16x32_bf16 v[10:13], v[50:53], v[34:37], v[10:13]
    ds_read_b64_tr_b16 v[50:51], v68 offset:8192
    ds_read_b64_tr_b16 v[52:53], v68 offset:10240
    s_waitcnt lgkmcnt(5)
    v_mfma_f32_16x16x32_bf16 v[14:17], v[54:57], v[26:29], v[14:17]
    v_mfma_f32_16x16x32_bf16 v[18:21], v[54:57], v[30:33], v[18:21]
    v_mfma_f32_16x16x32_bf16 v[22:25], v[54:57], v[34:37], v[22:25]
    ds_read_b64_tr_b16 v[54:55], v69 offset:8192
    ds_read_b64_tr_b16 v[56:57], v69 offset:10240
    s_waitcnt lgkmcnt(0)
    s_cmp_eq_u32 s57, 1
    s_cbranch_scc1 L39_wa
    s_waitcnt vmcnt(6)
    s_branch L39_wb
L39_wa:
    s_waitcnt vmcnt(4)
L39_wb:
    s_barrier
    ds_read_b128 v[26:29], v62 offset:0
    ds_read_b128 v[30:33], v62 offset:2048
    ds_read_b128 v[34:37], v62 offset:4096
    s_waitcnt lgkmcnt(5)
    v_mfma_f32_16x16x32_bf16 v[2:5], v[50:53], v[38:41], v[2:5]
    v_mfma_f32_16x16x32_bf16 v[6:9], v[50:53], v[42:45], v[6:9]
    v_mfma_f32_16x16x32_bf16 v[10:13], v[50:53], v[46:49], v[10:13]
    ds_read_b64_tr_b16 v[50:51], v70 offset:0
    ds_read_b64_tr_b16 v[52:53], v70 offset:2048
    s_waitcnt lgkmcnt(5)
    v_mfma_f32_16x16x32_bf16 v[14:17], v[54:57], v[38:41], v[14:17]
    v_mfma_f32_16x16x32_bf16 v[18:21], v[54:57], v[42:45], v[18:21]
    v_mfma_f32_16x16x32_bf16 v[22:25], v[54:57], v[46:49], v[22:25]
    ds_read_b64_tr_b16 v[54:55], v71 offset:0
    ds_read_b64_tr_b16 v[56:57], v71 offset:2048
    ds_read_b128 v[38:41], v63 offset:0
    ds_read_b128 v[42:45], v63 offset:2048
    ds_read_b128 v[46:49], v63 offset:4096
    s_waitcnt lgkmcnt(5)
    v_mfma_f32_16x16x32_bf16 v[2:5], v[50:53], v[26:29], v[2:5]
    v_mfma_f32_16x16x32_bf16 v[6:9], v[50:53], v[30:33], v[6:9]
    v_mfma_f32_16x16x32_bf16 v[10:13], v[50:53], v[34:37], v[10:13]
    ds_read_b64_tr_b16 v[50:51], v70 offset:8192
    ds_read_b64_tr_b16 v[52:53], v70 offset:10240
    s_waitcnt lgkmcnt(5)
    v_mfma_f32_16x16x32_bf16 v[14:17], v[54:57], v[26:29], v[14:17]
    v_mfma_f32_16x16x32_bf16 v[18:21], v[54:57], v[30:33], v[18:21]
    v_mfma_f32_16x16x32_bf16 v[22:25], v[54:57], v[34:37], v[22:25]
    ds_read_b64_tr_b16 v[54:55], v71 offset:8192
    ds_read_b64_tr_b16 v[56:57], v71 offset:10240
    s_waitcnt lgkmcnt(0)
    s_cmp_eq_u32 s57, 1
    s_cbranch_scc1 L40_wa
    s_waitcnt vmcnt(3)
    s_branch L40_wb
L40_wa:
    s_waitcnt vmcnt(2)
L40_wb:
    s_barrier
    ds_read_b128 v[26:29], v64 offset:0
    ds_read_b128 v[30:33], v64 offset:2048
    ds_read_b128 v[34:37], v64 offset:4096
    s_waitcnt lgkmcnt(5)
    v_mfma_f32_16x16x32_bf16 v[2:5], v[50:53], v[38:41], v[2:5]
    v_mfma_f32_16x16x32_bf16 v[6:9], v[50:53], v[42:45], v[6:9]
    v_mfma_f32_16x16x32_bf16 v[10:13], v[50:53], v[46:49], v[10:13]
    ds_read_b64_tr_b16 v[50:51], v72 offset:0
    ds_read_b64_tr_b16 v[52:53], v72 offset:2048
    s_waitcnt lgkmcnt(5)
    v_mfma_f32_16x16x32_bf16 v[14:17], v[54:57], v[38:41], v[14:17]
    v_mfma_f32_16x16x32_bf16 v[18:21], v[54:57], v[42:45], v[18:21]
    v_mfma_f32_16x16x32_bf16 v[22:25], v[54:57], v[46:49], v[22:25]
    ds_read_b64_tr_b16 v[54:55], v73 offset:0
    ds_read_b64_tr_b16 v[56:57], v73 offset:2048
    ds_read_b128 v[38:41], v65 offset:0
    ds_read_b128 v[42:45], v65 offset:2048
    ds_read_b128 v[46:49], v65 offset:4096
    s_waitcnt lgkmcnt(5)
    v_mfma_f32_16x16x32_bf16 v[2:5], v[50:53], v[26:29], v[2:5]
    v_mfma_f32_16x16x32_bf16 v[6:9], v[50:53], v[30:33], v[6:9]
    v_mfma_f32_16x16x32_bf16 v[10:13], v[50:53], v[34:37], v[10:13]
    ds_read_b64_tr_b16 v[50:51], v72 offset:8192
    ds_read_b64_tr_b16 v[52:53], v72 offset:10240
    s_waitcnt lgkmcnt(5)
    v_mfma_f32_16x16x32_bf16 v[14:17], v[54:57], v[26:29], v[14:17]
    v_mfma_f32_16x16x32_bf16 v[18:21], v[54:57], v[30:33], v[18:21]
    v_mfma_f32_16x16x32_bf16 v[22:25], v[54:57], v[34:37], v[22:25]
    ds_read_b64_tr_b16 v[54:55], v73 offset:8192
    ds_read_b64_tr_b16 v[56:57], v73 offset:10240
    s_waitcnt lgkmcnt(0)
    s_waitcnt vmcnt(0)
    s_barrier
    ds_read_b128 v[26:29], v58 offset:0
    ds_read_b128 v[30:33], v58 offset:2048
    ds_read_b128 v[34:37], v58 offset:4096
    s_waitcnt lgkmcnt(5)
    v_mfma_f32_16x16x32_bf16 v[2:5], v[50:53], v[38:41], v[2:5]
    v_mfma_f32_16x16x32_bf16 v[6:9], v[50:53], v[42:45], v[6:9]
    v_mfma_f32_16x16x32_bf16 v[10:13], v[50:53], v[46:49], v[10:13]
    ds_read_b64_tr_b16 v[50:51], v66 offset:0
    ds_read_b64_tr_b16 v[52:53], v66 offset:2048
    s_waitcnt lgkmcnt(5)
    v_mfma_f32_16x16x32_bf16 v[14:17], v[54:57], v[38:41], v[14:17]
    v_mfma_f32_16x16x32_bf16 v[18:21], v[54:57], v[42:45], v[18:21]
    v_mfma_f32_16x16x32_bf16 v[22:25], v[54:57], v[46:49], v[22:25]
    ds_read_b64_tr_b16 v[54:55], v67 offset:0
    ds_read_b64_tr_b16 v[56:57], v67 offset:2048
    ds_read_b128 v[38:41], v59 offset:0
    ds_read_b128 v[42:45], v59 offset:2048
    ds_read_b128 v[46:49], v59 offset:4096
    s_waitcnt lgkmcnt(5)
    v_mfma_f32_16x16x32_bf16 v[2:5], v[50:53], v[26:29], v[2:5]
    v_mfma_f32_16x16x32_bf16 v[6:9], v[50:53], v[30:33], v[6:9]
    v_mfma_f32_16x16x32_bf16 v[10:13], v[50:53], v[34:37], v[10:13]
    ds_read_b64_tr_b16 v[50:51], v66 offset:8192
    ds_read_b64_tr_b16 v[52:53], v66 offset:10240
    s_waitcnt lgkmcnt(5)
    v_mfma_f32_16x16x32_bf16 v[14:17], v[54:57], v[26:29], v[14:17]
    v_mfma_f32_16x16x32_bf16 v[18:21], v[54:57], v[30:33], v[18:21]
    v_mfma_f32_16x16x32_bf16 v[22:25], v[54:57], v[34:37], v[22:25]
    ds_read_b64_tr_b16 v[54:55], v67 offset:8192
    ds_read_b64_tr_b16 v[56:57], v67 offset:10240
    s_waitcnt lgkmcnt(2)
    v_mfma_f32_16x16x32_bf16 v[2:5], v[50:53], v[38:41], v[2:5]
    v_mfma_f32_16x16x32_bf16 v[6:9], v[50:53], v[42:45], v[6:9]
    v_mfma_f32_16x16x32_bf16 v[10:13], v[50:53], v[46:49], v[10:13]
    s_waitcnt lgkmcnt(0)
    v_mfma_f32_16x16x32_bf16 v[14:17], v[54:57], v[38:41], v[14:17]
    v_mfma_f32_16x16x32_bf16 v[18:21], v[54:57], v[42:45], v[18:21]
    v_mfma_f32_16x16x32_bf16 v[22:25], v[54:57], v[46:49], v[22:25]
    s_nop 1
    v_cvt_pk_bf16_f32 v2, v2, v3
    v_cvt_pk_bf16_f32 v3, v4, v5
    s_nop 1
    v_cvt_pk_bf16_f32 v14, v14, v15
    v_cvt_pk_bf16_f32 v15, v16, v17
    v_cvt_pk_bf16_f32 v6, v6, v7
    v_cvt_pk_bf16_f32 v7, v8, v9
    v_cvt_pk_bf16_f32 v18, v18, v19
    v_cvt_pk_bf16_f32 v19, v20, v21
    v_cvt_pk_bf16_f32 v10, v10, v11
    v_cvt_pk_bf16_f32 v11, v12, v13
    v_cvt_pk_bf16_f32 v22, v22, v23
    v_cvt_pk_bf16_f32 v23, v24, v25
    s_barrier
    ds_write_b32 v152, v2 offset:0
    ds_write_b32 v153, v3 offset:0
    ds_write_b32 v154, v14 offset:0
    ds_write_b32 v155, v15 offset:0
    ds_write_b32 v152, v6 offset:4864
    ds_write_b32 v153, v7 offset:4864
    ds_write_b32 v154, v18 offset:4864
    ds_write_b32 v155, v19 offset:4864
    ds_write_b32 v152, v10 offset:9728
    ds_write_b32 v153, v11 offset:9728
    ds_write_b32 v154, v22 offset:9728
    ds_write_b32 v155, v23 offset:9728
    s_waitcnt lgkmcnt(0)
    s_barrier
    s_cmp_ge_u32 s3, 8
    s_cbranch_scc1 L30_done
    s_lshr_b32 s4, s3, 2
    s_and_b32 s5, s3, 3
    s_lshl_b32 s5, s5, 5
    v_lshrrev_b32 v2, 1, v0
    v_add_u32 v2, s5, v2
    s_lshl_b32 s6, s68, 7
    v_add_u32 v3, s6, v2
    v_add_u32 v4, 16, v2
    v_mul_u32_u24 v4, 304, v4
    s_mul_i32 s5, s4, 48
    v_and_b32 v6, 1, v0
    v_lshl_add_u32 v4, v6, 4, v4
    v_add_u32 v4, s5, v4
    ds_read_b128 v[8:11], v4
    ds_read_b32 v12, v4 offset:16
    v_subrev_u32 v5, 4256, v4
    ds_read_b128 v[16:19], v5 offset:4352
    ds_read_b32 v20, v5 offset:4368
    ds_read_b128 v[22:25], v5 offset:3744
    ds_read_b32 v26, v5 offset:3760
    ds_read_b128 v[28:31], v5 offset:3136
    ds_read_b32 v32, v5 offset:3152
    ds_read_b128 v[34:37], v5 offset:2528
    ds_read_b32 v38, v5 offset:2544
    ds_read_b128 v[40:43], v5 offset:1920
    ds_read_b32 v44, v5 offset:1936
    ds_read_b128 v[46:49], v5 offset:1312
    ds_read_b32 v50, v5 offset:1328
    ds_read_b128 v[52:55], v5 offset:704
    ds_read_b32 v56, v5 offset:720
    ds_read_b128 v[58:61], v5 offset:96
    ds_read_b32 v62, v5 offset:112
    ds_read_b128 v[64:67], v5 offset:4448
    ds_read_b32 v68, v5 offset:4464
    ds_read_b128 v[70:73], v5 offset:3840
    ds_read_b32 v74, v5 offset:3856
    ds_read_b128 v[76:79], v5 offset:3232
    ds_read_b32 v80, v5 offset:3248
    ds_read_b128 v[82:85], v5 offset:2624
    ds_read_b32 v86, v5 offset:2640
    ds_read_b128 v[88:91], v5 offset:2016
    ds_read_b32 v92, v5 offset:2032
    ds_read_b128 v[94:97], v5 offset:1408
    ds_read_b32 v98, v5 offset:1424
    ds_read_b128 v[100:103], v5 offset:800
    ds_read_b32 v104, v5 offset:816
    ds_read_b128 v[106:109], v5 offset:192
    ds_read_b32 v110, v5 offset:208
    v_cmp_eq_u32 vcc, 1, v6
    s_waitcnt lgkmcnt(15)
    s_nop 0
    v_cndmask_b32 v8, v8, 0, vcc
    v_dot2_f32_bf16 v112, v8, v16, 0
    v_dot2_f32_bf16 v113, v8, v22, 0
    v_dot2_f32_bf16 v114, v8, v28, 0
    v_dot2_f32_bf16 v115, v8, v34, 0
    v_dot2_f32_bf16 v116, v8, v40, 0
    v_dot2_f32_bf16 v117, v8, v46, 0
    v_dot2_f32_bf16 v118, v8, v52, 0
    v_dot2_f32_bf16 v119, v8, v58, 0
    v_dot2_f32_bf16 v112, v9, v17, v112
    v_dot2_f32_bf16 v113, v9, v23, v113
    v_dot2_f32_bf16 v114, v9, v29, v114
    v_dot2_f32_bf16 v115, v9, v35, v115
    v_dot2_f32_bf16 v116, v9, v41, v116
    v_dot2_f32_bf16 v117, v9, v47, v117
    v_dot2_f32_bf16 v118, v9, v53, v118
    v_dot2_f32_bf16 v119, v9, v59, v119
    v_dot2_f32_bf16 v112, v10, v18, v112
    v_dot2_f32_bf16 v113, v10, v24, v113
    v_dot2_f32_bf16 v114, v10, v30, v114
    v_dot2_f32_bf16 v115, v10, v36, v115
    v_dot2_f32_bf16 v116, v10, v42, v116
    v_dot2_f32_bf16 v117, v10, v48, v117
    v_dot2_f32_bf16 v118, v10, v54, v118
    v_dot2_f32_bf16 v119, v10, v60, v119
    v_dot2_f32_bf16 v112, v11, v19, v112
    v_dot2_f32_bf16 v113, v11, v25, v113
    v_dot2_f32_bf16 v114, v11, v31, v114
    v_dot2_f32_bf16 v115, v11, v37, v115
    v_dot2_f32_bf16 v116, v11, v43, v116
    v_dot2_f32_bf16 v117, v11, v49, v117
    v_dot2_f32_bf16 v118, v11, v55, v118
    v_dot2_f32_bf16 v119, v11, v61, v119
    v_dot2_f32_bf16 v112, v12, v20, v112
    v_dot2_f32_bf16 v113, v12, v26, v113
    v_dot2_f32_bf16 v114, v12, v32, v114
    v_dot2_f32_bf16 v115, v12, v38, v115
    v_dot2_f32_bf16 v116, v12, v44, v116
    v_dot2_f32_bf16 v117, v12, v50, v117
    v_dot2_f32_bf16 v118, v12, v56, v118
    v_dot2_f32_bf16 v119, v12, v62, v119
    v_add_f32_dpp v112, v112, v112 quad_perm:[1,0,3,2] row_mask:0xf bank_mask:0xf
    v_add_f32_dpp v113, v113, v113 quad_perm:[1,0,3,2] row_mask:0xf bank_mask:0xf
    v_add_f32_dpp v114, v114, v114 quad_perm:[1,0,3,2] row_mask:0xf bank_mask:0xf
    v_add_f32_dpp v115, v115, v115 quad_perm:[1,0,3,2] row_mask:0xf bank_mask:0xf
    v_add_f32_dpp v116, v116, v116 quad_perm:[1,0,3,2] row_mask:0xf bank_mask:0xf
    v_add_f32_dpp v117, v117, v117 quad_perm:[1,0,3,2] row_mask:0xf bank_mask:0xf
    v_add_f32_dpp v118, v118, v118 quad_perm:[1,0,3,2] row_mask:0xf bank_mask:0xf
    v_add_f32_dpp v119, v119, v119 quad_perm:[1,0,3,2] row_mask:0xf bank_mask:0xf
    s_mov_b32 s6, 0x3e715bef
    v_cvt_pk_bf16_f32 v120, v112, v113
    v_lshlrev_b32 v112, 16, v120
    v_and_b32 v113, 0xffff0000, v120
    v_mul_f32 v112, s6, v112
    v_mul_f32 v113, s6, v113
    v_cvt_pk_bf16_f32 v120, v112, v113
    v_lshlrev_b32 v112, 16, v120
    v_and_b32 v113, 0xffff0000, v120
    v_cvt_pk_bf16_f32 v120, v114, v115
    v_lshlrev_b32 v114, 16, v120
    v_and_b32 v115, 0xffff0000, v120
    v_mul_f32 v114, s6, v114
    v_mul_f32 v115, s6, v115
    v_cvt_pk_bf16_f32 v120, v114, v115
    v_lshlrev_b32 v114, 16, v120
    v_and_b32 v115, 0xffff0000, v120
    v_cvt_pk_bf16_f32 v120, v116, v117
    v_lshlrev_b32 v116, 16, v120
    v_and_b32 v117, 0xffff0000, v120
    v_mul_f32 v116, s6, v116
    v_mul_f32 v117, s6, v117
    v_cvt_pk_bf16_f32 v120, v116, v117
    v_lshlrev_b32 v116, 16, v120
    v_and_b32 v117, 0xffff0000, v120
    v_cvt_pk_bf16_f32 v120, v118, v119
    v_lshlrev_b32 v118, 16, v120
    v_and_b32 v119, 0xffff0000, v120
    v_mul_f32 v118, s6, v118
    v_mul_f32 v119, s6, v119
    v_cvt_pk_bf16_f32 v120, v118, v119
    v_lshlrev_b32 v118, 16, v120
    v_and_b32 v119, 0xffff0000, v120
    s_cmp_lg_u32 s68, 0
    s_cbranch_scc1 L41_nomask
    v_mov_b32 v121, 0xce6e6b28
    v_cmp_gt_u32 vcc, 2, v3
    s_nop 1
    v_cndmask_b32 v113, v113, v121, vcc
    v_cmp_gt_u32 vcc, 4, v3
    s_nop 1
    v_cndmask_b32 v114, v114, v121, vcc
    v_cmp_gt_u32 vcc, 6, v3
    s_nop 1
    v_cndmask_b32 v115, v115, v121, vcc
    v_cmp_gt_u32 vcc, 8, v3
    s_nop 1
    v_cndmask_b32 v116, v116, v121, vcc
    v_cmp_gt_u32 vcc, 10, v3
    s_nop 1
    v_cndmask_b32 v117, v117, v121, vcc
    v_cmp_gt_u32 vcc, 12, v3
    s_nop 1
    v_cndmask_b32 v118, v118, v121, vcc
    v_cmp_gt_u32 vcc, 14, v3
    s_nop 1
    v_cndmask_b32 v119, v119, v121, vcc
L41_nomask:
    v_max3_f32 v120, v112, v113, v114
    v_max3_f32 v120, v120, v115, v116
    v_max3_f32 v120, v120, v117, v118
    v_max_f32 v120, v120, v119
    s_mov_b32 s6, 0x3fb8aa3b
    v_sub_f32 v112, v112, v120
    v_sub_f32 v113, v113, v120
    v_sub_f32 v114, v114, v120
    v_sub_f32 v115, v115, v120
    v_sub_f32 v116, v116, v120
    v_sub_f32 v117, v117, v120
    v_sub_f32 v118, v118, v120
    v_sub_f32 v119, v119, v120
    v_mul_f32 v112, s6, v112
    v_mul_f32 v113, s6, v113
    v_mul_f32 v114, s6, v114
    v_mul_f32 v115, s6, v115
    v_mul_f32 v116, s6, v116
    v_mul_f32 v117, s6, v117
    v_mul_f32 v118, s6, v118
    v_mul_f32 v119, s6, v119
    v_exp_f32 v112, v112
    v_exp_f32 v113, v113
    v_exp_f32 v114, v114
    v_exp_f32 v115, v115
    v_exp_f32 v116, v116
    v_exp_f32 v117, v117
    v_exp_f32 v118, v118
    v_exp_f32 v119, v119
    v_add_f32 v120, v112, v113
    v_add_f32 v120, v120, v114
    v_add_f32 v120, v120, v115
    v_add_f32 v120, v120, v116
    v_add_f32 v120, v120, v117
    v_add_f32 v120, v120, v118
    v_add_f32 v120, v120, v119
    v_rcp_f32 v120, v120
    s_nop 0
    v_mul_f32 v112, v112, v120
    v_mul_f32 v113, v113, v120
    v_mul_f32 v114, v114, v120
    v_mul_f32 v115, v115, v120
    v_mul_f32 v116, v116, v120
    v_mul_f32 v117, v117, v120
    v_mul_f32 v118, v118, v120
    v_mul_f32 v119, v119, v120
    v_cvt_pk_bf16_f32 v122, v112, v113
    v_cvt_pk_bf16_f32 v123, v114, v115
    v_cvt_pk_bf16_f32 v124, v116, v117
    v_cvt_pk_bf16_f32 v125, v118, v119
    s_mov_b32 s6, 0x05040100
    s_mov_b32 s7, 0x07060302
    s_waitcnt lgkmcnt(0)
    v_perm_b32 v140, v70, v64, s6
    v_perm_b32 v141, v70, v64, s7
    v_dot2_f32_bf16 v128, v140, v122, 0
    v_dot2_f32_bf16 v129, v141, v122, 0
    v_perm_b32 v142, v71, v65, s6
    v_perm_b32 v143, v71, v65, s7
    v_dot2_f32_bf16 v130, v142, v122, 0
    v_dot2_f32_bf16 v131, v143, v122, 0
    v_perm_b32 v144, v72, v66, s6
    v_perm_b32 v145, v72, v66, s7
    v_dot2_f32_bf16 v132, v144, v122, 0
    v_dot2_f32_bf16 v133, v145, v122, 0
    v_perm_b32 v146, v73, v67, s6
    v_perm_b32 v147, v73, v67, s7
    v_dot2_f32_bf16 v134, v146, v122, 0
    v_dot2_f32_bf16 v135, v147, v122, 0
    v_perm_b32 v140, v74, v68, s6
    v_perm_b32 v141, v74, v68, s7
    v_dot2_f32_bf16 v136, v140, v122, 0
    v_dot2_f32_bf16 v137, v141, v122, 0
    v_perm_b32 v140, v82, v76, s6
    v_perm_b32 v141, v82, v76, s7
    v_dot2_f32_bf16 v128, v140, v123, v128
    v_dot2_f32_bf16 v129, v141, v123, v129
    v_perm_b32 v142, v83, v77, s6
    v_perm_b32 v143, v83, v77, s7
    v_dot2_f32_bf16 v130, v142, v123, v130
    v_dot2_f32_bf16 v131, v143, v123, v131
    v_perm_b32 v144, v84, v78, s6
    v_perm_b32 v145, v84, v78, s7
    v_dot2_f32_bf16 v132, v144, v123, v132
    v_dot2_f32_bf16 v133, v145, v123, v133
    v_perm_b32 v146, v85, v79, s6
    v_perm_b32 v147, v85, v79, s7
    v_dot2_f32_bf16 v134, v146, v123, v134
    v_dot2_f32_bf16 v135, v147, v123, v135
    v_perm_b32 v140, v86, v80, s6
    v_perm_b32 v141, v86, v80, s7
    v_dot2_f32_bf16 v136, v140, v123, v136
    v_dot2_f32_bf16 v137, v141, v123, v137
    v_perm_b32 v140, v94, v88, s6
    v_perm_b32 v141, v94, v88, s7
    v_dot2_f32_bf16 v128, v140, v124, v128
    v_dot2_f32_bf16 v129, v141, v124, v129
    v_perm_b32 v142, v95, v89, s6
    v_perm_b32 v143, v95, v89, s7
    v_dot2_f32_bf16 v130, v142, v124, v130
    v_dot2_f32_bf16 v131, v143, v124, v131
    v_perm_b32 v144, v96, v90, s6
    v_perm_b32 v145, v96, v90, s7
    v_dot2_f32_bf16 v132, v144, v124, v132
    v_dot2_f32_bf16 v133, v145, v124, v133
    v_perm_b32 v146, v97, v91, s6
    v_perm_b32 v147, v97, v91, s7
    v_dot2_f32_bf16 v134, v146, v124, v134
    v_dot2_f32_bf16 v135, v147, v124, v135
    v_perm_b32 v140, v98, v92, s6
    v_perm_b32 v141, v98, v92, s7
    v_dot2_f32_bf16 v136, v140, v124, v136
    v_dot2_f32_bf16 v137, v141, v124, v137
    v_perm_b32 v140, v106, v100, s6
    v_perm_b32 v141, v106, v100, s7
    v_dot2_f32_bf16 v128, v140, v125, v128
    v_dot2_f32_bf16 v129, v141, v125, v129
    v_perm_b32 v142, v107, v101, s6
    v_perm_b32 v143, v107, v101, s7
    v_dot2_f32_bf16 v130, v142, v125, v130
    v_dot2_f32_bf16 v131, v143, v125, v131
    v_perm_b32 v144, v108, v102, s6
    v_perm_b32 v145, v108, v102, s7
    v_dot2_f32_bf16 v132, v144, v125, v132
    v_dot2_f32_bf16 v133, v145, v125, v133
    v_perm_b32 v146, v109, v103, s6
    v_perm_b32 v147, v109, v103, s7
    v_dot2_f32_bf16 v134, v146, v125, v134
    v_dot2_f32_bf16 v135, v147, v125, v135
    v_perm_b32 v140, v110, v104, s6
    v_perm_b32 v141, v110, v104, s7
    v_dot2_f32_bf16 v136, v140, v125, v136
    v_dot2_f32_bf16 v137, v141, v125, v137
    v_cvt_pk_bf16_f32 v8, v128, v129
    v_cvt_pk_bf16_f32 v9, v130, v131
    v_cvt_pk_bf16_f32 v10, v132, v133
    v_cvt_pk_bf16_f32 v11, v134, v135
    v_cvt_pk_bf16_f32 v12, v136, v137
    v_mul_u32_u24 v3, 1152, v3
    s_mul_i32 s5, s69, 72
    s_mul_i32 s6, s4, 36
    s_add_u32 s5, s5, s6
    v_lshl_add_u32 v3, v6, 4, v3
    v_add_u32 v3, s5, v3
    buffer_store_dwordx4 v[8:11], v3, s[20:23], 0 offen sc1
    s_mov_b32 s6, 0xaaaaaaaa
    s_mov_b32 s7, 0xaaaaaaaa
    s_mov_b64 exec, s[6:7]
    buffer_store_dword v12, v3, s[20:23], 0 offen offset:16 sc1
L30_done:
    s_mov_b64 exec, -1
    s_lshl_b32 s59, s68, 4
    s_add_u32 s59, s59, s69
    s_mov_b32 s31, s59
    s_load_dwordx2 s[64:65], s[0:1], 16
    s_load_dwordx2 s[66:67], s[0:1], 0
    s_and_b32 s68, s2, 7
    s_lshr_b32 s69, s2, 3
    s_lshl_b32 s68, s68, 3
    s_lshr_b32 s71, s69, 2
    s_add_u32 s68, s68, s71
    s_and_b32 s69, s69, 3
    s_mul_i32 s63, s3, 32768
    s_lshr_b32 s63, s63, 16
    s_mul_i32 s62, s63, 2
    s_sub_u32 s62, s3, s62
    v_lshrrev_b32 v3, 3, v0
    v_xor_b32 v2, v3, v0
    v_and_b32 v2, 7, v2
    v_lshlrev_b32 v2, 4, v2
    s_mov_b32 s5, 1152
    v_mul_lo_u32 v3, v3, s5
    v_add_u32 v22, v2, v3
    s_add_u32 s4, s3, 0
    s_mul_i32 s5, s4, 9216
    v_add_u32 v2, s5, v22
    s_sub_u32 s5, s4, 4
    s_cmp_ge_u32 s5, 9
    s_cselect_b32 s6, 9, 0
    s_cselect_b32 s7, 36864, 0
    s_sub_u32 s5, s5, s6
    s_cmp_ge_u32 s5, 9
    s_cselect_b32 s6, 9, 0
    s_sub_u32 s5, s5, s6
    s_lshl_b32 s5, s5, 6
    v_add_u32 v3, s5, v0
    v_mul_u32_u24 v4, 3641, v3
    v_lshrrev_b32 v4, 16, v4
    v_mul_u32_u24 v5, 18, v4
    v_sub_u32 v5, v3, v5
    v_lshlrev_b32 v5, 4, v5
    v_and_b32 v6, 0x13, v4
    v_and_b32 v7, 4, v4
    v_lshl_or_b32 v6, v7, 1, v6
    v_and_b32 v7, 8, v4
    v_lshrrev_b32 v7, 1, v7
    v_or_b32 v6, v6, v7
    s_mov_b32 s5, 1152
    v_mul_lo_u32 v6, v6, s5
    v_add3_u32 v5, v5, v6, s7
    s_cmp_lt_u32 s4, 4
    s_cselect_b64 vcc, -1, 0
    v_cndmask_b32 v43, v5, v2, vcc
    s_cselect_b32 s78, 2, 1152
    s_lshl_b32 s78, s78, 6
    s_mov_b32 s72, 0
    s_add_u32 s4, s3, 12
    s_mul_i32 s5, s4, 9216
    v_add_u32 v2, s5, v22
    s_sub_u32 s5, s4, 4
    s_cmp_ge_u32 s5, 9
    s_cselect_b32 s6, 9, 0
    s_cselect_b32 s7, 36864, 0
    s_sub_u32 s5, s5, s6
    s_cmp_ge_u32 s5, 9
    s_cselect_b32 s6, 9, 0
    s_sub_u32 s5, s5, s6
    s_lshl_b32 s5, s5, 6
    v_add_u32 v3, s5, v0
    v_mul_u32_u24 v4, 3641, v3
    v_lshrrev_b32 v4, 16, v4
    v_mul_u32_u24 v5, 18, v4
    v_sub_u32 v5, v3, v5
    v_lshlrev_b32 v5, 4, v5
    v_and_b32 v6, 0x13, v4
    v_and_b32 v7, 4, v4
    v_lshl_or_b32 v6, v7, 1, v6
    v_and_b32 v7, 8, v4
    v_lshrrev_b32 v7, 1, v7
    v_or_b32 v6, v6, v7
    s_mov_b32 s5, 1152
    v_mul_lo_u32 v6, v6, s5
    v_add3_u32 v5, v5, v6, s7
    s_cmp_lt_u32 s4, 4
    s_cselect_b64 vcc, -1, 0
    v_cndmask_b32 v44, v5, v2, vcc
    s_cselect_b32 s79, 2, 1152
    s_lshl_b32 s79, s79, 6
    s_mov_b32 s73, 0
    s_cmp_ge_u32 s4, 22
    s_cselect_b32 s57, 1, 0
    v_lshrrev_b32 v3, 4, v0
    v_xor_b32 v2, v3, v0
    v_and_b32 v2, 7, v2
    v_lshlrev_b32 v2, 4, v2
    v_and_b32 v3, 15, v0
    v_lshl_add_u32 v2, v3, 7, v2
    s_mul_i32 s4, s62, 2048
    v_add_u32 v2, s4, v2
    v_xor_b32 v3, 64, v2
    v_add_u32 v34, 0, v2
    v_add_u32 v35, 0, v3
    v_add_u32 v36, 45056, v2
    v_add_u32 v37, 45056, v3
    v_add_u32 v38, 90112, v2
    v_add_u32 v39, 90112, v3
    v_lshrrev_b32 v3, 5, v0
    v_lshlrev_b32 v3, 4, v3
    v_bfe_u32 v4, v0, 4, 1
    v_lshl_add_u32 v3, v4, 2, v3
    v_bfe_u32 v4, v0, 2, 2
    v_add_u32 v3, v3, v4
    v_and_b32 v5, 3, v0
    v_lshlrev_b32 v5, 3, v5
    v_mul_u32_u24 v6, 288, v3
    v_add_u32 v6, v6, v5
    s_mul_i32 s4, s63, 96
    v_add_u32 v6, s4, v6
    v_add_u32 v40, 4096, v6
    v_add_u32 v41, 49152, v6
    v_add_u32 v42, 94208, v6
    s_waitcnt lgkmcnt(0)
    s_mul_i32 s6, s68, 36864
    s_add_u32 s7, s6, 8388608
    s_add_u32 s8, s28, s7
    s_addc_u32 s9, s29, 0
    s_and_b32 s9, s9, 0xffff
    s_mov_b32 s10, 0
    s_mov_b32 s11, 0x00020000
    s_sub_u32 s10, 2359296, s6
    s_mul_i32 s6, s69, 288
    s_add_u32 s12, s64, s6
    s_addc_u32 s13, s65, 0
    s_and_b32 s13, s13, 0xffff
    s_mov_b32 s14, 0
    s_mov_b32 s15, 0x00020000
    s_sub_u32 s14, 663552, s6
    s_mov_b32 s16, s12
    s_mov_b32 s17, s13
    s_mov_b32 s18, s14
    s_mov_b32 s19, s15
    s_add_u32 s20, s28, 12582912
    s_addc_u32 s21, s29, 0
    s_and_b32 s21, s21, 0xffff
    s_mov_b32 s22, 2359296
    s_mov_b32 s23, 0x00020000
    s_add_u32 s24, s28, 58720256
    s_addc_u32 s25, s29, 0
    s_and_b32 s25, s25, 0xffff
    s_mov_b32 s26, 2359296
    s_mov_b32 s27, 0x00020000
    s_and_b32 s67, s67, 0xffff
    s_cmp_eq_u32 s99, 0
    s_cselect_b32 s24, s66, s24
    s_cselect_b32 s25, s67, s25
    s_add_u32 s4, s3, 0
    s_sub_u32 s5, s4, 4
    s_cmp_ge_u32 s5, 9
    s_cselect_b32 s6, 9, 0
    s_sub_u32 s5, s5, s6
    s_cmp_ge_u32 s5, 9
    s_cselect_b32 s32, s16, s12
    s_cselect_b32 s33, s17, s13
    s_cselect_b32 s34, s18, s14
    s_cselect_b32 s35, s19, s15
    s_cmp_lt_u32 s4, 4
    s_cselect_b32 s32, s8, s32
    s_cselect_b32 s33, s9, s33
    s_cselect_b32 s34, s10, s34
    s_cselect_b32 s35, s11, s35
    s_add_u32 s4, s3, 12
    s_sub_u32 s5, s4, 4
    s_cmp_ge_u32 s5, 9
    s_cselect_b32 s6, 9, 0
    s_sub_u32 s5, s5, s6
    s_cmp_ge_u32 s5, 9
    s_cselect_b32 s36, s16, s12
    s_cselect_b32 s37, s17, s13
    s_cselect_b32 s38, s18, s14
    s_cselect_b32 s39, s19, s15
    s_cmp_lt_u32 s4, 4
    s_cselect_b32 s36, s8, s36
    s_cselect_b32 s37, s9, s37
    s_cselect_b32 s38, s10, s38
    s_cselect_b32 s39, s11, s39
    s_waitcnt vmcnt(0)
    s_barrier
    s_cmp_lg_u32 s3, 0
    s_cbranch_scc1 L43_pub
    s_lshl_b32 s4, s31, 7
    s_add_u32 s4, s4, 0
    s_add_u32 s4, s4, s99
    v_mov_b32 v1, s4
    v_mov_b32 v2, s100
    v_mov_b32 v3, s101
    s_mov_b64 exec, 1
    buffer_store_dwordx2 v[2:3], v1, s[88:91], 0 offen sc1
    s_mov_b64 exec, -1
L43_pub:
L42_nopp:
    s_add_u32 s4, s3, 0
    s_cmp_lt_u32 s4, 4
    s_cbranch_scc1 L44_t
    s_add_u32 m0, s56, 0
    s_nop 0
    buffer_load_dwordx4 v43, s[32:35], s72 offen lds
    s_add_u32 s72, s72, s78
    s_add_u32 m0, s56, 22528
    s_nop 0
    buffer_load_dwordx4 v43, s[32:35], s72 offen lds
    s_add_u32 s72, s72, s78
    s_add_u32 m0, s56, 45056
    s_nop 0
    buffer_load_dwordx4 v43, s[32:35], s72 offen lds
    s_add_u32 s72, s72, s78
    s_add_u32 m0, s56, 67584
    s_nop 0
    buffer_load_dwordx4 v43, s[32:35], s72 offen lds
    s_add_u32 s72, s72, s78
    s_add_u32 m0, s56, 90112
    s_nop 0
    buffer_load_dwordx4 v43, s[32:35], s72 offen lds
    s_add_u32 s72, s72, s78
    s_add_u32 m0, s56, 112640
    s_nop 0
    buffer_load_dwordx4 v43, s[32:35], s72 offen lds
    s_add_u32 s72, s72, s78
L44_t:
    s_add_u32 s4, s3, 12
    s_cmp_lt_u32 s4, 4
    s_cbranch_scc1 L45_t
    s_cmp_eq_u32 s57, 1
    s_cbranch_scc1 L46_d
    s_add_u32 m0, s56, 12288
    s_nop 0
    buffer_load_dwordx4 v44, s[36:39], s73 offen lds
    s_add_u32 s73, s73, s79
L46_d:
    s_cmp_eq_u32 s57, 1
    s_cbranch_scc1 L47_d
    s_add_u32 m0, s56, 34816
    s_nop 0
    buffer_load_dwordx4 v44, s[36:39], s73 offen lds
    s_add_u32 s73, s73, s79
L47_d:
    s_cmp_eq_u32 s57, 1
    s_cbranch_scc1 L48_d
    s_add_u32 m0, s56, 57344
    s_nop 0
    buffer_load_dwordx4 v44, s[36:39], s73 offen lds
    s_add_u32 s73, s73, s79
L48_d:
    s_cmp_eq_u32 s57, 1
    s_cbranch_scc1 L49_d
    s_add_u32 m0, s56, 79872
    s_nop 0
    buffer_load_dwordx4 v44, s[36:39], s73 offen lds
    s_add_u32 s73, s73, s79
L49_d:
    s_cmp_eq_u32 s57, 1
    s_cbranch_scc1 L50_d
    s_add_u32 m0, s56, 102400
    s_nop 0
    buffer_load_dwordx4 v44, s[36:39], s73 offen lds
    s_add_u32 s73, s73, s79
L50_d:
    s_cmp_eq_u32 s57, 1
    s_cbranch_scc1 L51_d
    s_add_u32 m0, s56, 124928
    s_nop 0
    buffer_load_dwordx4 v44, s[36:39], s73 offen lds
    s_add_u32 s73, s73, s79
L51_d:
L45_t:
    s_lshr_b32 s59, s68, 2
    s_lshl_b32 s59, s59, 4
    s_cmp_lg_u32 s3, 0
    s_cbranch_scc1 L52_polln
    s_mov_b32 s6, 65535
    s_mov_b32 s7, 0
    s_mov_b64 exec, s[6:7]
    v_add_u32 v1, s59, v0
    v_lshlrev_b32 v1, 7, v1
    v_add_u32 v1, 0, v1
    v_add_u32 v1, s99, v1
    s_mov_b32 s5, 0
L52_poll:
    buffer_load_dwordx2 v[2:3], v1, s[88:91], 0 offen sc1
    s_waitcnt vmcnt(0)
    v_cmp_ne_u64 vcc, s[100:101], v[2:3]
    s_add_u32 s5, s5, 1
    s_cmp_gt_u32 s5, 0x40000
    s_cbranch_scc1 L52_pollx
    s_cbranch_vccz L52_pollx
    s_sleep 1
    s_branch L52_poll
L52_pollx:
    s_mov_b64 exec, -1
L52_polln:
    s_barrier
    s_lshl_b32 s4, s68, 5
    s_mul_i32 s5, s62, 16
    s_add_u32 s4, s4, s5
    v_and_b32 v80, 15, v0
    v_add_u32 v80, s4, v80
    v_mul_u32_u24 v80, 1152, v80
    s_mul_i32 s4, s69, 288
    s_mul_i32 s5, s63, 96
    s_add_u32 s4, s4, s5
    v_lshrrev_b32 v81, 4, v0
    v_lshlrev_b32 v81, 3, v81
    v_add3_u32 v80, v80, v81, s4
    buffer_load_dwordx2 v[64:65], v80, s[24:27], 0 offen offset:0
    buffer_load_dwordx2 v[66:67], v80, s[24:27], 0 offen offset:32
    buffer_load_dwordx2 v[68:69], v80, s[24:27], 0 offen offset:64
    s_cmp_ge_u32 s3, 4
    s_cbranch_scc1 L53_ta
    s_add_u32 m0, s56, 0
    s_nop 0
    buffer_load_dwordx4 v43, s[32:35], s72 offen lds
    s_add_u32 s72, s72, s78
L53_ta:
    s_cmp_ge_u32 s3, 4
    s_cbranch_scc1 L54_ta
    s_add_u32 m0, s56, 22528
    s_nop 0
    buffer_load_dwordx4 v43, s[32:35], s72 offen lds
    s_add_u32 s72, s72, s78
L54_ta:
    s_cmp_ge_u32 s3, 4
    s_cbranch_scc1 L55_ta
    s_add_u32 m0, s56, 45056
    s_nop 0
    buffer_load_dwordx4 v43, s[32:35], s72 offen lds
    s_add_u32 s72, s72, s78
L55_ta:
    s_cmp_ge_u32 s3, 4
    s_cbranch_scc1 L56_ta
    s_add_u32 m0, s56, 67584
    s_nop 0
    buffer_load_dwordx4 v43, s[32:35], s72 offen lds
    s_add_u32 s72, s72, s78
L56_ta:
    s_cmp_ge_u32 s3, 4
    s_cbranch_scc1 L57_ta
    s_add_u32 m0, s56, 90112
    s_nop 0
    buffer_load_dwordx4 v43, s[32:35], s72 offen lds
    s_add_u32 s72, s72, s78
L57_ta:
    s_cmp_ge_u32 s3, 4
    s_cbranch_scc1 L58_ta
    s_add_u32 m0, s56, 112640
    s_nop 0
    buffer_load_dwordx4 v43, s[32:35], s72 offen lds
    s_add_u32 s72, s72, s78
L58_ta:
    s_cmp_ge_u32 s3, 4
    s_cbranch_scc1 L59_awa
    s_waitcnt vmcnt(5)
    s_branch L59_awb
L59_awa:
    s_waitcnt vmcnt(0)
L59_awb:
    s_barrier
    s_cmp_ge_u32 s3, 6
    s_cbranch_scc1 L61_idle
    ds_read_b128 v[14:17], v34 offset:0
    ds_read_b64_tr_b16 v[22:23], v40 offset:0
    ds_read_b64_tr_b16 v[24:25], v40 offset:2304
    ds_read_b64_tr_b16 v[26:27], v40 offset:32
    ds_read_b64_tr_b16 v[28:29], v40 offset:2336
    ds_read_b64_tr_b16 v[30:31], v40 offset:64
    ds_read_b64_tr_b16 v[32:33], v40 offset:2368
    ds_read_b128 v[18:21], v35 offset:0
    s_waitcnt lgkmcnt(5)
    v_mfma_f32_16x16x32_bf16 v[2:5], v[22:25], v[14:17], 0
    ds_read_b64_tr_b16 v[22:23], v40 offset:9216
    ds_read_b64_tr_b16 v[24:25], v40 offset:11520
    s_waitcnt lgkmcnt(5)
    v_mfma_f32_16x16x32_bf16 v[6:9], v[26:29], v[14:17], 0
    ds_read_b64_tr_b16 v[26:27], v40 offset:9248
    ds_read_b64_tr_b16 v[28:29], v40 offset:11552
    s_waitcnt lgkmcnt(5)
    v_mfma_f32_16x16x32_bf16 v[10:13], v[30:33], v[14:17], 0
    ds_read_b64_tr_b16 v[30:31], v40 offset:9280
    ds_read_b64_tr_b16 v[32:33], v40 offset:11584
    s_waitcnt lgkmcnt(0)
    s_waitcnt vmcnt(0)
    s_barrier
    ds_read_b128 v[14:17], v34 offset:22528
    s_waitcnt lgkmcnt(5)
    v_mfma_f32_16x16x32_bf16 v[2:5], v[22:25], v[18:21], v[2:5]
    ds_read_b64_tr_b16 v[22:23], v40 offset:22528
    ds_read_b64_tr_b16 v[24:25], v40 offset:24832
    s_add_u32 m0, s56, 0
    s_nop 0
    buffer_load_dwordx4 v43, s[32:35], s72 offen lds
    s_add_u32 s72, s72, s78
    s_waitcnt lgkmcnt(5)
    v_mfma_f32_16x16x32_bf16 v[6:9], v[26:29], v[18:21], v[6:9]
    ds_read_b64_tr_b16 v[26:27], v40 offset:22560
    ds_read_b64_tr_b16 v[28:29], v40 offset:24864
    s_waitcnt lgkmcnt(5)
    v_mfma_f32_16x16x32_bf16 v[10:13], v[30:33], v[18:21], v[10:13]
    ds_read_b64_tr_b16 v[30:31], v40 offset:22592
    ds_read_b64_tr_b16 v[32:33], v40 offset:24896
    s_cmp_eq_u32 s57, 1
    s_cbranch_scc1 L62_d
    s_add_u32 m0, s56, 12288
    s_nop 0
    buffer_load_dwordx4 v44, s[36:39], s73 offen lds
    s_add_u32 s73, s73, s79
L62_d:
    ds_read_b128 v[18:21], v35 offset:22528
    s_waitcnt lgkmcnt(5)
    v_mfma_f32_16x16x32_bf16 v[2:5], v[22:25], v[14:17], v[2:5]
    ds_read_b64_tr_b16 v[22:23], v40 offset:31744
    ds_read_b64_tr_b16 v[24:25], v40 offset:34048
    s_waitcnt lgkmcnt(5)
    v_mfma_f32_16x16x32_bf16 v[6:9], v[26:29], v[14:17], v[6:9]
    ds_read_b64_tr_b16 v[26:27], v40 offset:31776
    ds_read_b64_tr_b16 v[28:29], v40 offset:34080
    s_waitcnt lgkmcnt(5)
    v_mfma_f32_16x16x32_bf16 v[10:13], v[30:33], v[14:17], v[10:13]
    ds_read_b64_tr_b16 v[30:31], v40 offset:31808
    ds_read_b64_tr_b16 v[32:33], v40 offset:34112
    s_waitcnt lgkmcnt(0)
    s_barrier
    ds_read_b128 v[14:17], v36 offset:0
    s_waitcnt lgkmcnt(5)
    v_mfma_f32_16x16x32_bf16 v[2:5], v[22:25], v[18:21], v[2:5]
    ds_read_b64_tr_b16 v[22:23], v41 offset:0
    ds_read_b64_tr_b16 v[24:25], v41 offset:2304
    s_add_u32 m0, s56, 22528
    s_nop 0
    buffer_load_dwordx4 v43, s[32:35], s72 offen lds
    s_add_u32 s72, s72, s78
    s_waitcnt lgkmcnt(5)
    v_mfma_f32_16x16x32_bf16 v[6:9], v[26:29], v[18:21], v[6:9]
    ds_read_b64_tr_b16 v[26:27], v41 offset:32
    ds_read_b64_tr_b16 v[28:29], v41 offset:2336
    s_waitcnt lgkmcnt(5)
    v_mfma_f32_16x16x32_bf16 v[10:13], v[30:33], v[18:21], v[10:13]
    ds_read_b64_tr_b16 v[30:31], v41 offset:64
    ds_read_b64_tr_b16 v[32:33], v41 offset:2368
    s_cmp_eq_u32 s57, 1
    s_cbranch_scc1 L63_d
    s_add_u32 m0, s56, 34816
    s_nop 0
    buffer_load_dwordx4 v44, s[36:39], s73 offen lds
    s_add_u32 s73, s73, s79
L63_d:
    ds_read_b128 v[18:21], v37 offset:0
    s_waitcnt lgkmcnt(5)
    v_mfma_f32_16x16x32_bf16 v[2:5], v[22:25], v[14:17], v[2:5]
    ds_read_b64_tr_b16 v[22:23], v41 offset:9216
    ds_read_b64_tr_b16 v[24:25], v41 offset:11520
    s_waitcnt lgkmcnt(5)
    v_mfma_f32_16x16x32_bf16 v[6:9], v[26:29], v[14:17], v[6:9]
    ds_read_b64_tr_b16 v[26:27], v41 offset:9248
    ds_read_b64_tr_b16 v[28:29], v41 offset:11552
    s_waitcnt lgkmcnt(5)
    v_mfma_f32_16x16x32_bf16 v[10:13], v[30:33], v[14:17], v[10:13]
    ds_read_b64_tr_b16 v[30:31], v41 offset:9280
    ds_read_b64_tr_b16 v[32:33], v41 offset:11584
    s_waitcnt lgkmcnt(0)
    s_barrier
    ds_read_b128 v[14:17], v36 offset:22528
    s_waitcnt lgkmcnt(5)
    v_mfma_f32_16x16x32_bf16 v[2:5], v[22:25], v[18:21], v[2:5]
    ds_read_b64_tr_b16 v[22:23], v41 offset:22528
    ds_read_b64_tr_b16 v[24:25], v41 offset:24832
    s_add_u32 m0, s56, 45056
    s_nop 0
    buffer_load_dwordx4 v43, s[32:35], s72 offen lds
    s_add_u32 s72, s72, s78
    s_waitcnt lgkmcnt(5)
    v_mfma_f32_16x16x32_bf16 v[6:9], v[26:29], v[18:21], v[6:9]
    ds_read_b64_tr_b16 v[26:27], v41 offset:22560
    ds_read_b64_tr_b16 v[28:29], v41 offset:24864
    s_waitcnt lgkmcnt(5)
    v_mfma_f32_16x16x32_bf16 v[10:13], v[30:33], v[18:21], v[10:13]
    ds_read_b64_tr_b16 v[30:31], v41 offset:22592
    ds_read_b64_tr_b16 v[32:33], v41 offset:24896
    s_cmp_eq_u32 s57, 1
    s_cbranch_scc1 L64_d
    s_add_u32 m0, s56, 57344
    s_nop 0
    buffer_load_dwordx4 v44, s[36:39], s73 offen lds
    s_add_u32 s73, s73, s79
L64_d:
    ds_read_b128 v[18:21], v37 offset:22528
    s_waitcnt lgkmcnt(5)
    v_mfma_f32_16x16x32_bf16 v[2:5], v[22:25], v[14:17], v[2:5]
    ds_read_b64_tr_b16 v[22:23], v41 offset:31744
    ds_read_b64_tr_b16 v[24:25], v41 offset:34048
    s_waitcnt lgkmcnt(5)
    v_mfma_f32_16x16x32_bf16 v[6:9], v[26:29], v[14:17], v[6:9]
    ds_read_b64_tr_b16 v[26:27], v41 offset:31776
    ds_read_b64_tr_b16 v[28:29], v41 offset:34080
    s_waitcnt lgkmcnt(5)
    v_mfma_f32_16x16x32_bf16 v[10:13], v[30:33], v[14:17], v[10:13]
    ds_read_b64_tr_b16 v[30:31], v41 offset:31808
    ds_read_b64_tr_b16 v[32:33], v41 offset:34112
    s_waitcnt lgkmcnt(0)
    s_barrier
    ds_read_b128 v[14:17], v38 offset:0
    s_waitcnt lgkmcnt(5)
    v_mfma_f32_16x16x32_bf16 v[2:5], v[22:25], v[18:21], v[2:5]
    ds_read_b64_tr_b16 v[22:23], v42 offset:0
    ds_read_b64_tr_b16 v[24:25], v42 offset:2304
    s_waitcnt lgkmcnt(5)
    v_mfma_f32_16x16x32_bf16 v[6:9], v[26:29], v[18:21], v[6:9]
    ds_read_b64_tr_b16 v[26:27], v42 offset:32
    ds_read_b64_tr_b16 v[28:29], v42 offset:2336
    s_waitcnt lgkmcnt(5)
    v_mfma_f32_16x16x32_bf16 v[10:13], v[30:33], v[18:21], v[10:13]
    ds_read_b64_tr_b16 v[30:31], v42 offset:64
    ds_read_b64_tr_b16 v[32:33], v42 offset:2368
    ds_read_b128 v[18:21], v39 offset:0
    s_waitcnt lgkmcnt(5)
    v_mfma_f32_16x16x32_bf16 v[2:5], v[22:25], v[14:17], v[2:5]
    ds_read_b64_tr_b16 v[22:23], v42 offset:9216
    ds_read_b64_tr_b16 v[24:25], v42 offset:11520
    s_waitcnt lgkmcnt(5)
    v_mfma_f32_16x16x32_bf16 v[6:9], v[26:29], v[14:17], v[6:9]
    ds_read_b64_tr_b16 v[26:27], v42 offset:9248
    ds_read_b64_tr_b16 v[28:29], v42 offset:11552
    s_waitcnt lgkmcnt(5)
    v_mfma_f32_16x16x32_bf16 v[10:13], v[30:33], v[14:17], v[10:13]
    ds_read_b64_tr_b16 v[30:31], v42 offset:9280
    ds_read_b64_tr_b16 v[32:33], v42 offset:11584
    s_waitcnt lgkmcnt(0)
    s_barrier
    ds_read_b128 v[14:17], v38 offset:22528
    s_waitcnt lgkmcnt(5)
    v_mfma_f32_16x16x32_bf16 v[2:5], v[22:25], v[18:21], v[2:5]
    ds_read_b64_tr_b16 v[22:23], v42 offset:22528
    ds_read_b64_tr_b16 v[24:25], v42 offset:24832
    s_waitcnt lgkmcnt(5)
    v_mfma_f32_16x16x32_bf16 v[6:9], v[26:29], v[18:21], v[6:9]
    ds_read_b64_tr_b16 v[26:27], v42 offset:22560
    ds_read_b64_tr_b16 v[28:29], v42 offset:24864
    s_waitcnt lgkmcnt(5)
    v_mfma_f32_16x16x32_bf16 v[10:13], v[30:33], v[18:21], v[10:13]
    ds_read_b64_tr_b16 v[30:31], v42 offset:22592
    ds_read_b64_tr_b16 v[32:33], v42 offset:24896
    ds_read_b128 v[18:21], v39 offset:22528
    s_waitcnt lgkmcnt(5)
    v_mfma_f32_16x16x32_bf16 v[2:5], v[22:25], v[14:17], v[2:5]
    ds_read_b64_tr_b16 v[22:23], v42 offset:31744
    ds_read_b64_tr_b16 v[24:25], v42 offset:34048
    s_waitcnt lgkmcnt(5)
    v_mfma_f32_16x16x32_bf16 v[6:9], v[26:29], v[14:17], v[6:9]
    ds_read_b64_tr_b16 v[26:27], v42 offset:31776
    ds_read_b64_tr_b16 v[28:29], v42 offset:34080
    s_waitcnt lgkmcnt(5)
    v_mfma_f32_16x16x32_bf16 v[10:13], v[30:33], v[14:17], v[10:13]
    ds_read_b64_tr_b16 v[30:31], v42 offset:31808
    ds_read_b64_tr_b16 v[32:33], v42 offset:34112
    s_waitcnt lgkmcnt(0)
    s_cmp_eq_u32 s57, 1
    s_cbranch_scc1 L65_wa
    s_waitcnt vmcnt(4)
    s_branch L65_wb
L65_wa:
    s_waitcnt vmcnt(2)
L65_wb:
    s_barrier
    ds_read_b128 v[14:17], v34 offset:0
    s_waitcnt lgkmcnt(5)
    v_mfma_f32_16x16x32_bf16 v[2:5], v[22:25], v[18:21], v[2:5]
    ds_read_b64_tr_b16 v[22:23], v40 offset:0
    ds_read_b64_tr_b16 v[24:25], v40 offset:2304
    s_waitcnt lgkmcnt(5)
    v_mfma_f32_16x16x32_bf16 v[6:9], v[26:29], v[18:21], v[6:9]
    ds_read_b64_tr_b16 v[26:27], v40 offset:32
    ds_read_b64_tr_b16 v[28:29], v40 offset:2336
    s_waitcnt lgkmcnt(5)
    v_mfma_f32_16x16x32_bf16 v[10:13], v[30:33], v[18:21], v[10:13]
    ds_read_b64_tr_b16 v[30:31], v40 offset:64
    ds_read_b64_tr_b16 v[32:33], v40 offset:2368
    ds_read_b128 v[18:21], v35 offset:0
    s_waitcnt lgkmcnt(5)
    v_mfma_f32_16x16x32_bf16 v[2:5], v[22:25], v[14:17], v[2:5]
    ds_read_b64_tr_b16 v[22:23], v40 offset:9216
    ds_read_b64_tr_b16 v[24:25], v40 offset:11520
    s_waitcnt lgkmcnt(5)
    v_mfma_f32_16x16x32_bf16 v[6:9], v[26:29], v[14:17], v[6:9]
    ds_read_b64_tr_b16 v[26:27], v40 offset:9248
    ds_read_b64_tr_b16 v[28:29], v40 offset:11552
    s_waitcnt lgkmcnt(5)
    v_mfma_f32_16x16x32_bf16 v[10:13], v[30:33], v[14:17], v[10:13]
    ds_read_b64_tr_b16 v[30:31], v40 offset:9280
    ds_read_b64_tr_b16 v[32:33], v40 offset:11584
    s_waitcnt lgkmcnt(0)
    s_cmp_eq_u32 s57, 1
    s_cbranch_scc1 L66_wa
    s_waitcnt vmcnt(2)
    s_branch L66_wb
L66_wa:
    s_waitcnt vmcnt(1)
L66_wb:
    s_barrier
    ds_read_b128 v[14:17], v34 offset:22528
    s_waitcnt lgkmcnt(5)
    v_mfma_f32_16x16x32_bf16 v[2:5], v[22:25], v[18:21], v[2:5]
    ds_read_b64_tr_b16 v[22:23], v40 offset:22528
    ds_read_b64_tr_b16 v[24:25], v40 offset:24832
    s_waitcnt lgkmcnt(5)
    v_mfma_f32_16x16x32_bf16 v[6:9], v[26:29], v[18:21], v[6:9]
    ds_read_b64_tr_b16 v[26:27], v40 offset:22560
    ds_read_b64_tr_b16 v[28:29], v40 offset:24864
    s_waitcnt lgkmcnt(5)
    v_mfma_f32_16x16x32_bf16 v[10:13], v[30:33], v[18:21], v[10:13]
    ds_read_b64_tr_b16 v[30:31], v40 offset:22592
    ds_read_b64_tr_b16 v[32:33], v40 offset:24896
    ds_read_b128 v[18:21], v35 offset:22528
    s_waitcnt lgkmcnt(5)
    v_mfma_f32_16x16x32_bf16 v[2:5], v[22:25], v[14:17], v[2:5]
    ds_read_b64_tr_b16 v[22:23], v40 offset:31744
    ds_read_b64_tr_b16 v[24:25], v40 offset:34048
    s_waitcnt lgkmcnt(5)
    v_mfma_f32_16x16x32_bf16 v[6:9], v[26:29], v[14:17], v[6:9]
    ds_read_b64_tr_b16 v[26:27], v40 offset:31776
    ds_read_b64_tr_b16 v[28:29], v40 offset:34080
    s_waitcnt lgkmcnt(5)
    v_mfma_f32_16x16x32_bf16 v[10:13], v[30:33], v[14:17], v[10:13]
    ds_read_b64_tr_b16 v[30:31], v40 offset:31808
    ds_read_b64_tr_b16 v[32:33], v40 offset:34112
    s_waitcnt lgkmcnt(0)
    s_waitcnt vmcnt(0)
    s_barrier
    ds_read_b128 v[14:17], v36 offset:0
    s_waitcnt lgkmcnt(5)
    v_mfma_f32_16x16x32_bf16 v[2:5], v[22:25], v[18:21], v[2:5]
    ds_read_b64_tr_b16 v[22:23], v41 offset:0
    ds_read_b64_tr_b16 v[24:25], v41 offset:2304
    s_waitcnt lgkmcnt(5)
    v_mfma_f32_16x16x32_bf16 v[6:9], v[26:29], v[18:21], v[6:9]
    ds_read_b64_tr_b16 v[26:27], v41 offset:32
    ds_read_b64_tr_b16 v[28:29], v41 offset:2336
    s_waitcnt lgkmcnt(5)
    v_mfma_f32_16x16x32_bf16 v[10:13], v[30:33], v[18:21], v[10:13]
    ds_read_b64_tr_b16 v[30:31], v41 offset:64
    ds_read_b64_tr_b16 v[32:33], v41 offset:2368
    ds_read_b128 v[18:21], v37 offset:0
    s_waitcnt lgkmcnt(5)
    v_mfma_f32_16x16x32_bf16 v[2:5], v[22:25], v[14:17], v[2:5]
    ds_read_b64_tr_b16 v[22:23], v41 offset:9216
    ds_read_b64_tr_b16 v[24:25], v41 offset:11520
    s_waitcnt lgkmcnt(5)
    v_mfma_f32_16x16x32_bf16 v[6:9], v[26:29], v[14:17], v[6:9]
    ds_read_b64_tr_b16 v[26:27], v41 offset:9248
    ds_read_b64_tr_b16 v[28:29], v41 offset:11552
    s_waitcnt lgkmcnt(5)
    v_mfma_f32_16x16x32_bf16 v[10:13], v[30:33], v[14:17], v[10:13]
    ds_read_b64_tr_b16 v[30:31], v41 offset:9280
    ds_read_b64_tr_b16 v[32:33], v41 offset:11584
    s_waitcnt lgkmcnt(4)
    v_mfma_f32_16x16x32_bf16 v[2:5], v[22:25], v[18:21], v[2:5]
    s_waitcnt lgkmcnt(2)
    v_mfma_f32_16x16x32_bf16 v[6:9], v[26:29], v[18:21], v[6:9]
    s_waitcnt lgkmcnt(0)
    v_mfma_f32_16x16x32_bf16 v[10:13], v[30:33], v[18:21], v[10:13]
    s_nop 3
    v_cvt_pk_bf16_f32 v72, v2, v3
    v_cvt_pk_bf16_f32 v73, v4, v5
    v_lshlrev_b32 v2, 16, v72
    v_and_b32 v3, 0xffff0000, v72
    v_lshlrev_b32 v4, 16, v73
    v_and_b32 v5, 0xffff0000, v73
    v_lshlrev_b32 v74, 16, v64
    v_and_b32 v75, 0xffff0000, v64
    v_lshlrev_b32 v76, 16, v65
    v_and_b32 v77, 0xffff0000, v65
    v_add_f32 v2, v2, v74
    v_add_f32 v3, v3, v75
    v_add_f32 v4, v4, v76
    v_add_f32 v5, v5, v77
    v_cvt_pk_bf16_f32 v2, v2, v3
    v_cvt_pk_bf16_f32 v3, v4, v5
    buffer_store_dwordx2 v[2:3], v80, s[20:23], 0 offen offset:0 sc1
    v_cvt_pk_bf16_f32 v72, v6, v7
    v_cvt_pk_bf16_f32 v73, v8, v9
    v_lshlrev_b32 v6, 16, v72
    v_and_b32 v7, 0xffff0000, v72
    v_lshlrev_b32 v8, 16, v73
    v_and_b32 v9, 0xffff0000, v73
    v_lshlrev_b32 v74, 16, v66
    v_and_b32 v75, 0xffff0000, v66
    v_lshlrev_b32 v76, 16, v67
    v_and_b32 v77, 0xffff0000, v67
    v_add_f32 v6, v6, v74
    v_add_f32 v7, v7, v75
    v_add_f32 v8, v8, v76
    v_add_f32 v9, v9, v77
    v_cvt_pk_bf16_f32 v6, v6, v7
    v_cvt_pk_bf16_f32 v7, v8, v9
    buffer_store_dwordx2 v[6:7], v80, s[20:23], 0 offen offset:32 sc1
    v_cvt_pk_bf16_f32 v72, v10, v11
    v_cvt_pk_bf16_f32 v73, v12, v13
    v_lshlrev_b32 v10, 16, v72
    v_and_b32 v11, 0xffff0000, v72
    v_lshlrev_b32 v12, 16, v73
    v_and_b32 v13, 0xffff0000, v73
    v_lshlrev_b32 v74, 16, v68
    v_and_b32 v75, 0xffff0000, v68
    v_lshlrev_b32 v76, 16, v69
    v_and_b32 v77, 0xffff0000, v69
    v_add_f32 v10, v10, v74
    v_add_f32 v11, v11, v75
    v_add_f32 v12, v12, v76
    v_add_f32 v13, v13, v77
    v_cvt_pk_bf16_f32 v10, v10, v11
    v_cvt_pk_bf16_f32 v11, v12, v13
    buffer_store_dwordx2 v[10:11], v80, s[20:23], 0 offen offset:64 sc1
    s_branch L60_done
L61_idle:
    s_waitcnt vmcnt(0)
    s_barrier
    s_add_u32 m0, s56, 0
    s_nop 0
    buffer_load_dwordx4 v43, s[32:35], s72 offen lds
    s_add_u32 s72, s72, s78
    s_cmp_eq_u32 s57, 1
    s_cbranch_scc1 L67_d
    s_add_u32 m0, s56, 12288
    s_nop 0
    buffer_load_dwordx4 v44, s[36:39], s73 offen lds
    s_add_u32 s73, s73, s79
L67_d:
    s_barrier
    s_add_u32 m0, s56, 22528
    s_nop 0
    buffer_load_dwordx4 v43, s[32:35], s72 offen lds
    s_add_u32 s72, s72, s78
    s_cmp_eq_u32 s57, 1
    s_cbranch_scc1 L68_d
    s_add_u32 m0, s56, 34816
    s_nop 0
    buffer_load_dwordx4 v44, s[36:39], s73 offen lds
    s_add_u32 s73, s73, s79
L68_d:
    s_barrier
    s_add_u32 m0, s56, 45056
    s_nop 0
    buffer_load_dwordx4 v43, s[32:35], s72 offen lds
    s_add_u32 s72, s72, s78
    s_cmp_eq_u32 s57, 1
    s_cbranch_scc1 L69_d
    s_add_u32 m0, s56, 57344
    s_nop 0
    buffer_load_dwordx4 v44, s[36:39], s73 offen lds
    s_add_u32 s73, s73, s79
L69_d:
    s_barrier
    s_barrier
    s_cmp_eq_u32 s57, 1
    s_cbranch_scc1 L70_wa
    s_waitcnt vmcnt(4)
    s_branch L70_wb
L70_wa:
    s_waitcnt vmcnt(2)
L70_wb:
    s_barrier
    s_cmp_eq_u32 s57, 1
    s_cbranch_scc1 L71_wa
    s_waitcnt vmcnt(2)
    s_branch L71_wb
L71_wa:
    s_waitcnt vmcnt(1)
L71_wb:
    s_barrier
    s_waitcnt vmcnt(0)
    s_barrier
L60_done:
    s_mov_b64 exec, -1
    s_lshl_b32 s59, s68, 2
    s_add_u32 s59, s59, s69
    s_mov_b32 s31, s59
    s_load_dwordx4 s[64:67], s[0:1], 32
    s_and_b32 s68, s2, 7
    s_lshr_b32 s69, s2, 3
    s_and_b32 s70, s69, 3
    s_lshl_b32 s68, s68, 2
    s_add_u32 s68, s68, s70
    s_lshr_b32 s69, s69, 2
    s_mul_i32 s63, s3, 16384
    s_lshr_b32 s63, s63, 16
    s_mul_i32 s62, s63, 4
    s_sub_u32 s62, s3, s62
    v_lshrrev_b32 v3, 3, v0
    v_xor_b32 v2, v3, v0
    v_and_b32 v2, 7, v2
    v_lshlrev_b32 v2, 4, v2
    s_mov_b32 s5, 1152
    v_mul_lo_u32 v3, v3, s5
    v_add_u32 v130, v2, v3
    s_add_u32 s4, s3, 0
    s_mul_i32 s5, s4, 9216
    v_add_u32 v2, s5, v130
    s_sub_u32 s5, s4, 32
    s_cmp_ge_u32 s5, 18
    s_cselect_b32 s6, 18, 0
    s_cselect_b32 s7, 294912, 0
    s_sub_u32 s5, s5, s6
    s_cmp_ge_u32 s5, 9
    s_cselect_b32 s6, 9, 0
    s_sub_u32 s5, s5, s6
    s_lshl_b32 s5, s5, 6
    v_add_u32 v3, s5, v0
    v_mul_u32_u24 v4, 3641, v3
    v_lshrrev_b32 v4, 16, v4
    v_mul_u32_u24 v5, 18, v4
    v_sub_u32 v5, v3, v5
    v_lshlrev_b32 v5, 4, v5
    v_and_b32 v6, 0x13, v4
    v_and_b32 v7, 4, v4
    v_lshl_or_b32 v6, v7, 1, v6
    v_and_b32 v7, 8, v4
    v_lshrrev_b32 v7, 1, v7
    v_or_b32 v6, v6, v7
    s_mov_b32 s5, 9216
    v_mul_lo_u32 v6, v6, s5
    v_add3_u32 v5, v5, v6, s7
    s_cmp_lt_u32 s4, 32
    s_cselect_b64 vcc, -1, 0
    v_cndmask_b32 v160, v5, v2, vcc
    s_cselect_b32 s78, 2, 9216
    s_lshl_b32 s78, s78, 6
    s_mov_b32 s72, 0
    s_add_u32 s4, s3, 12
    s_mul_i32 s5, s4, 9216
    v_add_u32 v2, s5, v130
    s_sub_u32 s5, s4, 32
    s_cmp_ge_u32 s5, 18
    s_cselect_b32 s6, 18, 0
    s_cselect_b32 s7, 294912, 0
    s_sub_u32 s5, s5, s6
    s_cmp_ge_u32 s5, 9
    s_cselect_b32 s6, 9, 0
    s_sub_u32 s5, s5, s6
    s_lshl_b32 s5, s5, 6
    v_add_u32 v3, s5, v0
    v_mul_u32_u24 v4, 3641, v3
    v_lshrrev_b32 v4, 16, v4
    v_mul_u32_u24 v5, 18, v4
    v_sub_u32 v5, v3, v5
    v_lshlrev_b32 v5, 4, v5
    v_and_b32 v6, 0x13, v4
    v_and_b32 v7, 4, v4
    v_lshl_or_b32 v6, v7, 1, v6
    v_and_b32 v7, 8, v4
    v_lshrrev_b32 v7, 1, v7
    v_or_b32 v6, v6, v7
    s_mov_b32 s5, 9216
    v_mul_lo_u32 v6, v6, s5
    v_add3_u32 v5, v5, v6, s7
    s_cmp_lt_u32 s4, 32
    s_cselect_b64 vcc, -1, 0
    v_cndmask_b32 v161, v5, v2, vcc
    s_cselect_b32 s79, 2, 9216
    s_lshl_b32 s79, s79, 6
    s_mov_b32 s73, 0
    s_add_u32 s4, s3, 24
    s_mul_i32 s5, s4, 9216
    v_add_u32 v2, s5, v130
    s_sub_u32 s5, s4, 32
    s_cmp_ge_u32 s5, 18
    s_cselect_b32 s6, 18, 0
    s_cselect_b32 s7, 294912, 0
    s_sub_u32 s5, s5, s6
    s_cmp_ge_u32 s5, 9
    s_cselect_b32 s6, 9, 0
    s_sub_u32 s5, s5, s6
    s_lshl_b32 s5, s5, 6
    v_add_u32 v3, s5, v0
    v_mul_u32_u24 v4, 3641, v3
    v_lshrrev_b32 v4, 16, v4
    v_mul_u32_u24 v5, 18, v4
    v_sub_u32 v5, v3, v5
    v_lshlrev_b32 v5, 4, v5
    v_and_b32 v6, 0x13, v4
    v_and_b32 v7, 4, v4
    v_lshl_or_b32 v6, v7, 1, v6
    v_and_b32 v7, 8, v4
    v_lshrrev_b32 v7, 1, v7
    v_or_b32 v6, v6, v7
    s_mov_b32 s5, 9216
    v_mul_lo_u32 v6, v6, s5
    v_add3_u32 v5, v5, v6, s7
    s_cmp_lt_u32 s4, 32
    s_cselect_b64 vcc, -1, 0
    v_cndmask_b32 v162, v5, v2, vcc
    s_cselect_b32 s80, 2, 9216
    s_lshl_b32 s80, s80, 6
    s_mov_b32 s74, 0
    s_add_u32 s4, s3, 36
    s_mul_i32 s5, s4, 9216
    v_add_u32 v2, s5, v130
    s_sub_u32 s5, s4, 32
    s_cmp_ge_u32 s5, 18
    s_cselect_b32 s6, 18, 0
    s_cselect_b32 s7, 294912, 0
    s_sub_u32 s5, s5, s6
    s_cmp_ge_u32 s5, 9
    s_cselect_b32 s6, 9, 0
    s_sub_u32 s5, s5, s6
    s_lshl_b32 s5, s5, 6
    v_add_u32 v3, s5, v0
    v_mul_u32_u24 v4, 3641, v3
    v_lshrrev_b32 v4, 16, v4
    v_mul_u32_u24 v5, 18, v4
    v_sub_u32 v5, v3, v5
    v_lshlrev_b32 v5, 4, v5
    v_and_b32 v6, 0x13, v4
    v_and_b32 v7, 4, v4
    v_lshl_or_b32 v6, v7, 1, v6
    v_and_b32 v7, 8, v4
    v_lshrrev_b32 v7, 1, v7
    v_or_b32 v6, v6, v7
    s_mov_b32 s5, 9216
    v_mul_lo_u32 v6, v6, s5
    v_add3_u32 v5, v5, v6, s7
    s_cmp_lt_u32 s4, 32
    s_cselect_b64 vcc, -1, 0
    v_cndmask_b32 v163, v5, v2, vcc
    s_cselect_b32 s81, 2, 9216
    s_lshl_b32 s81, s81, 6
    s_mov_b32 s75, 0
    s_add_u32 s4, s3, 48
    s_mul_i32 s5, s4, 9216
    v_add_u32 v2, s5, v130
    s_sub_u32 s5, s4, 32
    s_cmp_ge_u32 s5, 18
    s_cselect_b32 s6, 18, 0
    s_cselect_b32 s7, 294912, 0
    s_sub_u32 s5, s5, s6
    s_cmp_ge_u32 s5, 9
    s_cselect_b32 s6, 9, 0
    s_sub_u32 s5, s5, s6
    s_lshl_b32 s5, s5, 6
    v_add_u32 v3, s5, v0
    v_mul_u32_u24 v4, 3641, v3
    v_lshrrev_b32 v4, 16, v4
    v_mul_u32_u24 v5, 18, v4
    v_sub_u32 v5, v3, v5
    v_lshlrev_b32 v5, 4, v5
    v_and_b32 v6, 0x13, v4
    v_and_b32 v7, 4, v4
    v_lshl_or_b32 v6, v7, 1, v6
    v_and_b32 v7, 8, v4
    v_lshrrev_b32 v7, 1, v7
    v_or_b32 v6, v6, v7
    s_mov_b32 s5, 9216
    v_mul_lo_u32 v6, v6, s5
    v_add3_u32 v5, v5, v6, s7
    s_cmp_lt_u32 s4, 32
    s_cselect_b64 vcc, -1, 0
    v_cndmask_b32 v164, v5, v2, vcc
    s_cselect_b32 s82, 2, 9216
    s_lshl_b32 s82, s82, 6
    s_mov_b32 s76, 0
    s_add_u32 s4, s3, 60
    s_mul_i32 s5, s4, 9216
    v_add_u32 v2, s5, v130
    s_sub_u32 s5, s4, 32
    s_cmp_ge_u32 s5, 18
    s_cselect_b32 s6, 18, 0
    s_cselect_b32 s7, 294912, 0
    s_sub_u32 s5, s5, s6
    s_cmp_ge_u32 s5, 9
    s_cselect_b32 s6, 9, 0
    s_sub_u32 s5, s5, s6
    s_lshl_b32 s5, s5, 6
    v_add_u32 v3, s5, v0
    v_mul_u32_u24 v4, 3641, v3
    v_lshrrev_b32 v4, 16, v4
    v_mul_u32_u24 v5, 18, v4
    v_sub_u32 v5, v3, v5
    v_lshlrev_b32 v5, 4, v5
    v_and_b32 v6, 0x13, v4
    v_and_b32 v7, 4, v4
    v_lshl_or_b32 v6, v7, 1, v6
    v_and_b32 v7, 8, v4
    v_lshrrev_b32 v7, 1, v7
    v_or_b32 v6, v6, v7
    s_mov_b32 s5, 9216
    v_mul_lo_u32 v6, v6, s5
    v_add3_u32 v5, v5, v6, s7
    s_cmp_lt_u32 s4, 32
    s_cselect_b64 vcc, -1, 0
    v_cndmask_b32 v165, v5, v2, vcc
    s_cselect_b32 s83, 2, 9216
    s_lshl_b32 s83, s83, 6
    s_mov_b32 s77, 0
    s_cmp_ge_u32 s4, 68
    s_cselect_b32 s57, 1, 0
    v_lshrrev_b32 v3, 4, v0
    v_xor_b32 v2, v3, v0
    v_and_b32 v2, 7, v2
    v_lshlrev_b32 v2, 4, v2
    v_and_b32 v3, 15, v0
    v_lshl_add_u32 v2, v3, 7, v2
    s_mul_i32 s4, s62, 8192
    v_add_u32 v2, s4, v2
    v_xor_b32 v3, 64, v2
    v_add_u32 v154, 0, v2
    v_add_u32 v155, 0, v3
    v_add_u32 v156, 69632, v2
    v_add_u32 v157, 69632, v3
    v_lshrrev_b32 v3, 5, v0
    v_lshlrev_b32 v3, 4, v3
    v_bfe_u32 v4, v0, 4, 1
    v_lshl_add_u32 v3, v4, 2, v3
    v_bfe_u32 v4, v0, 2, 2
    v_add_u32 v3, v3, v4
    v_and_b32 v5, 3, v0
    v_lshlrev_b32 v5, 3, v5
    v_mul_u32_u24 v6, 288, v3
    v_add_u32 v6, v6, v5
    s_mul_i32 s4, s63, 96
    v_add_u32 v6, s4, v6
    v_add_u32 v158, 32768, v6
    v_add_u32 v159, 102400, v6
    s_waitcnt lgkmcnt(0)
    s_mul_i32 s6, s69, 294912
    s_add_u32 s7, s6, 4194304
    s_add_u32 s8, s28, s7
    s_addc_u32 s9, s29, 0
    s_and_b32 s9, s9, 0xffff
    s_mov_b32 s10, 0
    s_mov_b32 s11, 0x00020000
    s_sub_u32 s10, 2359296, s6
    s_mul_i32 s6, s68, 288
    s_add_u32 s12, s64, s6
    s_addc_u32 s13, s65, 0
    s_and_b32 s13, s13, 0xffff
    s_mov_b32 s14, 0
    s_mov_b32 s15, 0x00020000
    s_sub_u32 s14, 5308416, s6
    s_add_u32 s16, s66, s6
    s_addc_u32 s17, s67, 0
    s_and_b32 s17, s17, 0xffff
    s_mov_b32 s18, 0
    s_mov_b32 s19, 0x00020000
    s_sub_u32 s18, 5308416, s6
    s_add_u32 s20, s28, 16777216
    s_addc_u32 s21, s29, 0
    s_and_b32 s21, s21, 0xffff
    s_mov_b32 s22, 18874368
    s_mov_b32 s23, 0x00020000
    s_add_u32 s4, s3, 0
    s_sub_u32 s5, s4, 32
    s_cmp_ge_u32 s5, 18
    s_cselect_b32 s6, 18, 0
    s_sub_u32 s5, s5, s6
    s_cmp_ge_u32 s5, 9
    s_cselect_b32 s32, s16, s12
    s_cselect_b32 s33, s17, s13
    s_cselect_b32 s34, s18, s14
    s_cselect_b32 s35, s19, s15
    s_cmp_lt_u32 s4, 32
    s_cselect_b32 s32, s8, s32
    s_cselect_b32 s33, s9, s33
    s_cselect_b32 s34, s10, s34
    s_cselect_b32 s35, s11, s35
    s_add_u32 s4, s3, 12
    s_sub_u32 s5, s4, 32
    s_cmp_ge_u32 s5, 18
    s_cselect_b32 s6, 18, 0
    s_sub_u32 s5, s5, s6
    s_cmp_ge_u32 s5, 9
    s_cselect_b32 s36, s16, s12
    s_cselect_b32 s37, s17, s13
    s_cselect_b32 s38, s18, s14
    s_cselect_b32 s39, s19, s15
    s_cmp_lt_u32 s4, 32
    s_cselect_b32 s36, s8, s36
    s_cselect_b32 s37, s9, s37
    s_cselect_b32 s38, s10, s38
    s_cselect_b32 s39, s11, s39
    s_add_u32 s4, s3, 24
    s_sub_u32 s5, s4, 32
    s_cmp_ge_u32 s5, 18
    s_cselect_b32 s6, 18, 0
    s_sub_u32 s5, s5, s6
    s_cmp_ge_u32 s5, 9
    s_cselect_b32 s40, s16, s12
    s_cselect_b32 s41, s17, s13
    s_cselect_b32 s42, s18, s14
    s_cselect_b32 s43, s19, s15
    s_cmp_lt_u32 s4, 32
    s_cselect_b32 s40, s8, s40
    s_cselect_b32 s41, s9, s41
    s_cselect_b32 s42, s10, s42
    s_cselect_b32 s43, s11, s43
    s_add_u32 s4, s3, 36
    s_sub_u32 s5, s4, 32
    s_cmp_ge_u32 s5, 18
    s_cselect_b32 s6, 18, 0
    s_sub_u32 s5, s5, s6
    s_cmp_ge_u32 s5, 9
    s_cselect_b32 s44, s16, s12
    s_cselect_b32 s45, s17, s13
    s_cselect_b32 s46, s18, s14
    s_cselect_b32 s47, s19, s15
    s_cmp_lt_u32 s4, 32
    s_cselect_b32 s44, s8, s44
    s_cselect_b32 s45, s9, s45
    s_cselect_b32 s46, s10, s46
    s_cselect_b32 s47, s11, s47
    s_add_u32 s4, s3, 48
    s_sub_u32 s5, s4, 32
    s_cmp_ge_u32 s5, 18
    s_cselect_b32 s6, 18, 0
    s_sub_u32 s5, s5, s6
    s_cmp_ge_u32 s5, 9
    s_cselect_b32 s48, s16, s12
    s_cselect_b32 s49, s17, s13
    s_cselect_b32 s50, s18, s14
    s_cselect_b32 s51, s19, s15
    s_cmp_lt_u32 s4, 32
    s_cselect_b32 s48, s8, s48
    s_cselect_b32 s49, s9, s49
    s_cselect_b32 s50, s10, s50
    s_cselect_b32 s51, s11, s51
    s_add_u32 s4, s3, 60
    s_sub_u32 s5, s4, 32
    s_cmp_ge_u32 s5, 18
    s_cselect_b32 s6, 18, 0
    s_sub_u32 s5, s5, s6
    s_cmp_ge_u32 s5, 9
    s_cselect_b32 s52, s16, s12
    s_cselect_b32 s53, s17, s13
    s_cselect_b32 s54, s18, s14
    s_cselect_b32 s55, s19, s15
    s_cmp_lt_u32 s4, 32
    s_cselect_b32 s52, s8, s52
    s_cselect_b32 s53, s9, s53
    s_cselect_b32 s54, s10, s54
    s_cselect_b32 s55, s11, s55
    s_waitcnt vmcnt(0)
    s_barrier
    s_cmp_lg_u32 s3, 0
    s_cbranch_scc1 L73_pub
    s_lshl_b32 s4, s31, 7
    s_add_u32 s4, s4, 65536
    s_add_u32 s4, s4, s99
    v_mov_b32 v1, s4
    v_mov_b32 v2, s100
    v_mov_b32 v3, s101
    s_mov_b64 exec, 1
    buffer_store_dwordx2 v[2:3], v1, s[88:91], 0 offen sc1
    s_mov_b64 exec, -1
L73_pub:
L72_nopp:
    s_add_u32 s4, s3, 0
    s_cmp_lt_u32 s4, 32
    s_cbranch_scc1 L74_t
    s_add_u32 m0, s56, 0
    s_nop 0
    buffer_load_dwordx4 v160, s[32:35], s72 offen lds
    s_add_u32 s72, s72, s78
    s_add_u32 m0, s56, 69632
    s_nop 0
    buffer_load_dwordx4 v160, s[32:35], s72 offen lds
    s_add_u32 s72, s72, s78
L74_t:
    s_add_u32 s4, s3, 12
    s_cmp_lt_u32 s4, 32
    s_cbranch_scc1 L75_t
    s_add_u32 m0, s56, 12288
    s_nop 0
    buffer_load_dwordx4 v161, s[36:39], s73 offen lds
    s_add_u32 s73, s73, s79
    s_add_u32 m0, s56, 81920
    s_nop 0
    buffer_load_dwordx4 v161, s[36:39], s73 offen lds
    s_add_u32 s73, s73, s79
L75_t:
    s_add_u32 s4, s3, 24
    s_cmp_lt_u32 s4, 32
    s_cbranch_scc1 L76_t
    s_add_u32 m0, s56, 24576
    s_nop 0
    buffer_load_dwordx4 v162, s[40:43], s74 offen lds
    s_add_u32 s74, s74, s80
    s_add_u32 m0, s56, 94208
    s_nop 0
    buffer_load_dwordx4 v162, s[40:43], s74 offen lds
    s_add_u32 s74, s74, s80
L76_t:
    s_add_u32 s4, s3, 36
    s_cmp_lt_u32 s4, 32
    s_cbranch_scc1 L77_t
    s_add_u32 m0, s56, 36864
    s_nop 0
    buffer_load_dwordx4 v163, s[44:47], s75 offen lds
    s_add_u32 s75, s75, s81
    s_add_u32 m0, s56, 106496
    s_nop 0
    buffer_load_dwordx4 v163, s[44:47], s75 offen lds
    s_add_u32 s75, s75, s81
L77_t:
    s_add_u32 s4, s3, 48
    s_cmp_lt_u32 s4, 32
    s_cbranch_scc1 L78_t
    s_add_u32 m0, s56, 49152
    s_nop 0
    buffer_load_dwordx4 v164, s[48:51], s76 offen lds
    s_add_u32 s76, s76, s82
    s_add_u32 m0, s56, 118784
    s_nop 0
    buffer_load_dwordx4 v164, s[48:51], s76 offen lds
    s_add_u32 s76, s76, s82
L78_t:
    s_add_u32 s4, s3, 60
    s_cmp_lt_u32 s4, 32
    s_cbranch_scc1 L79_t
    s_cmp_eq_u32 s57, 1
    s_cbranch_scc1 L80_d
    s_add_u32 m0, s56, 61440
    s_nop 0
    buffer_load_dwordx4 v165, s[52:55], s77 offen lds
    s_add_u32 s77, s77, s83
L80_d:
    s_cmp_eq_u32 s57, 1
    s_cbranch_scc1 L81_d
    s_add_u32 m0, s56, 131072
    s_nop 0
    buffer_load_dwordx4 v165, s[52:55], s77 offen lds
    s_add_u32 s77, s77, s83
L81_d:
L79_t:
    s_lshl_b32 s59, s69, 5
    s_lshr_b32 s60, s2, 2
    s_lshl_b32 s60, s60, 2
    s_cmp_lg_u32 s3, 0
    s_cbranch_scc1 L84_polln
    s_mov_b32 s6, 15
    s_mov_b32 s7, 0
    s_mov_b64 exec, s[6:7]
    v_add_u32 v1, s60, v0
    v_lshlrev_b32 v1, 7, v1
    v_add_u32 v1, 65536, v1
    v_add_u32 v1, s99, v1
    s_mov_b32 s5, 0
L84_poll:
    buffer_load_dwordx2 v[2:3], v1, s[88:91], 0 offen sc1
    s_waitcnt vmcnt(0)
    v_cmp_ne_u64 vcc, s[100:101], v[2:3]
    s_add_u32 s5, s5, 1
    s_cmp_gt_u32 s5, 0x40000
    s_cbranch_scc1 L84_pollx
    s_cbranch_vccz L84_pollx
    s_sleep 1
    s_branch L84_poll
L84_pollx:
    s_mov_b64 exec, -1
L84_polln:
    s_barrier
    s_cmp_ge_u32 s3, 8
    s_cbranch_scc1 L85_lnskip
    s_add_u32 s84, s28, 12582912
    s_addc_u32 s85, s29, 0
    s_and_b32 s85, s85, 0xffff
    s_mov_b32 s86, 2359296
    s_mov_b32 s87, 0x00020000
    s_add_u32 s20, s28, 4194304
    s_addc_u32 s21, s29, 0
    s_and_b32 s21, s21, 0xffff
    s_mov_b32 s22, 2359296
    s_mov_b32 s23, 0x00020000
    s_lshl_b32 s58, s2, 3
    s_add_u32 s58, s58, s3
    s_mul_i32 s64, s58, 1152
    v_lshlrev_b32 v2, 4, v0
    v_mov_b32 v8, 0
    v_mov_b32 v9, 0
    v_mov_b32 v10, 0
    v_mov_b32 v11, 0
    buffer_load_dwordx4 v[4:7], v2, s[84:87], s64 offen
    s_mov_b64 exec, 0xff
    buffer_load_dwordx4 v[8:11], v2, s[84:87], s64 offen offset:1024
    s_mov_b64 exec, -1
    s_waitcnt vmcnt(0)
    v_lshlrev_b32 v16, 16, v4
    v_and_b32 v17, 0xffff0000, v4
    v_lshlrev_b32 v18, 16, v5
    v_and_b32 v19, 0xffff0000, v5
    v_lshlrev_b32 v20, 16, v6
    v_and_b32 v21, 0xffff0000, v6
    v_lshlrev_b32 v22, 16, v7
    v_and_b32 v23, 0xffff0000, v7
    v_lshlrev_b32 v24, 16, v8
    v_and_b32 v25, 0xffff0000, v8
    v_lshlrev_b32 v26, 16, v9
    v_and_b32 v27, 0xffff0000, v9
    v_lshlrev_b32 v28, 16, v10
    v_and_b32 v29, 0xffff0000, v10
    v_lshlrev_b32 v30, 16, v11
    v_and_b32 v31, 0xffff0000, v11
    v_add_f32 v48, v16, v17
    v_add_f32 v48, v48, v18
    v_add_f32 v48, v48, v19
    v_add_f32 v48, v48, v20
    v_add_f32 v48, v48, v21
    v_add_f32 v48, v48, v22
    v_add_f32 v48, v48, v23
    v_add_f32 v48, v48, v24
    v_add_f32 v48, v48, v25
    v_add_f32 v48, v48, v26
    v_add_f32 v48, v48, v27
    v_add_f32 v48, v48, v28
    v_add_f32 v48, v48, v29
    v_add_f32 v48, v48, v30
    v_add_f32 v48, v48, v31
    s_nop 1
    v_add_f32_dpp v48, v48, v48 row_shr:1 row_mask:0xf bank_mask:0xf
    s_nop 1
    v_add_f32_dpp v48, v48, v48 row_shr:2 row_mask:0xf bank_mask:0xf
    s_nop 1
    v_add_f32_dpp v48, v48, v48 row_shr:4 row_mask:0xf bank_mask:0xf
    s_nop 1
    v_add_f32_dpp v48, v48, v48 row_shr:8 row_mask:0xf bank_mask:0xf
    s_nop 1
    v_add_f32_dpp v48, v48, v48 row_bcast:15 row_mask:0xa bank_mask:0xf
    s_nop 1
    v_add_f32_dpp v48, v48, v48 row_bcast:31 row_mask:0xc bank_mask:0xf
    s_nop 0
    v_readlane_b32 s70, v48, 63
    s_mov_b32 s71, 0x3ae38e39
    s_nop 0
    v_mov_b32 v49, s70
    v_mul_f32 v49, s71, v49
    v_mov_b32 v50, 0
    v_mov_b32 v51, 0
    v_sub_f32 v52, v16, v49
    v_fmac_f32 v50, v52, v52
    v_sub_f32 v52, v17, v49
    v_fmac_f32 v50, v52, v52
    v_sub_f32 v52, v18, v49
    v_fmac_f32 v50, v52, v52
    v_sub_f32 v52, v19, v49
    v_fmac_f32 v50, v52, v52
    v_sub_f32 v52, v20, v49
    v_fmac_f32 v50, v52, v52
    v_sub_f32 v52, v21, v49
    v_fmac_f32 v50, v52, v52
    v_sub_f32 v52, v22, v49
    v_fmac_f32 v50, v52, v52
    v_sub_f32 v52, v23, v49
    v_fmac_f32 v50, v52, v52
    s_mov_b64 exec, 0xff
    v_sub_f32 v52, v24, v49
    v_fmac_f32 v51, v52, v52
    v_sub_f32 v52, v25, v49
    v_fmac_f32 v51, v52, v52
    v_sub_f32 v52, v26, v49
    v_fmac_f32 v51, v52, v52
    v_sub_f32 v52, v27, v49
    v_fmac_f32 v51, v52, v52
    v_sub_f32 v52, v28, v49
    v_fmac_f32 v51, v52, v52
    v_sub_f32 v52, v29, v49
    v_fmac_f32 v51, v52, v52
    v_sub_f32 v52, v30, v49
    v_fmac_f32 v51, v52, v52
    v_sub_f32 v52, v31, v49
    v_fmac_f32 v51, v52, v52
    s_mov_b64 exec, -1
    v_add_f32 v50, v50, v51
    s_nop 1
    v_add_f32_dpp v50, v50, v50 row_shr:1 row_mask:0xf bank_mask:0xf
    s_nop 1
    v_add_f32_dpp v50, v50, v50 row_shr:2 row_mask:0xf bank_mask:0xf
    s_nop 1
    v_add_f32_dpp v50, v50, v50 row_shr:4 row_mask:0xf bank_mask:0xf
    s_nop 1
    v_add_f32_dpp v50, v50, v50 row_shr:8 row_mask:0xf bank_mask:0xf
    s_nop 1
    v_add_f32_dpp v50, v50, v50 row_bcast:15 row_mask:0xa bank_mask:0xf
    s_nop 1
    v_add_f32_dpp v50, v50, v50 row_bcast:31 row_mask:0xc bank_mask:0xf
    s_nop 0
    v_readlane_b32 s70, v50, 63
    s_nop 1
    v_mov_b32 v51, s70
    v_mul_f32 v51, s71, v51
    v_cvt_pk_bf16_f32 v52, v49, v51
    v_lshlrev_b32 v49, 16, v52
    v_and_b32 v51, 0xffff0000, v52
    v_add_f32 v51, 0x3727c5ac, v51
    v_cvt_pk_bf16_f32 v52, v51, v51
    v_lshlrev_b32 v51, 16, v52
    v_sqrt_f32 v51, v51
    s_nop 0
    v_cvt_pk_bf16_f32 v52, v51, v51
    v_lshlrev_b32 v51, 16, v52
    v_rcp_f32 v51, v51
    v_sub_f32 v16, v16, v49
    v_sub_f32 v17, v17, v49
    v_sub_f32 v18, v18, v49
    v_sub_f32 v19, v19, v49
    v_sub_f32 v20, v20, v49
    v_sub_f32 v21, v21, v49
    v_sub_f32 v22, v22, v49
    v_sub_f32 v23, v23, v49
    v_sub_f32 v24, v24, v49
    v_sub_f32 v25, v25, v49
    v_sub_f32 v26, v26, v49
    v_sub_f32 v27, v27, v49
    v_sub_f32 v28, v28, v49
    v_sub_f32 v29, v29, v49
    v_sub_f32 v30, v30, v49
    v_sub_f32 v31, v31, v49
    v_cvt_pk_bf16_f32 v56, v16, v17
    v_cvt_pk_bf16_f32 v57, v18, v19
    v_cvt_pk_bf16_f32 v58, v20, v21
    v_cvt_pk_bf16_f32 v59, v22, v23
    v_cvt_pk_bf16_f32 v60, v24, v25
    v_cvt_pk_bf16_f32 v61, v26, v27
    v_cvt_pk_bf16_f32 v62, v28, v29
    v_cvt_pk_bf16_f32 v63, v30, v31
    v_lshlrev_b32 v16, 16, v56
    v_and_b32 v17, 0xffff0000, v56
    v_lshlrev_b32 v18, 16, v57
    v_and_b32 v19, 0xffff0000, v57
    v_lshlrev_b32 v20, 16, v58
    v_and_b32 v21, 0xffff0000, v58
    v_lshlrev_b32 v22, 16, v59
    v_and_b32 v23, 0xffff0000, v59
    v_lshlrev_b32 v24, 16, v60
    v_and_b32 v25, 0xffff0000, v60
    v_lshlrev_b32 v26, 16, v61
    v_and_b32 v27, 0xffff0000, v61
    v_lshlrev_b32 v28, 16, v62
    v_and_b32 v29, 0xffff0000, v62
    v_lshlrev_b32 v30, 16, v63
    v_and_b32 v31, 0xffff0000, v63
    v_mul_f32 v16, v16, v51
    v_mul_f32 v17, v17, v51
    v_mul_f32 v18, v18, v51
    v_mul_f32 v19, v19, v51
    v_mul_f32 v20, v20, v51
    v_mul_f32 v21, v21, v51
    v_mul_f32 v22, v22, v51
    v_mul_f32 v23, v23, v51
    v_mul_f32 v24, v24, v51
    v_mul_f32 v25, v25, v51
    v_mul_f32 v26, v26, v51
    v_mul_f32 v27, v27, v51
    v_mul_f32 v28, v28, v51
    v_mul_f32 v29, v29, v51
    v_mul_f32 v30, v30, v51
    v_mul_f32 v31, v31, v51
    v_cvt_pk_bf16_f32 v56, v16, v17
    v_cvt_pk_bf16_f32 v57, v18, v19
    v_cvt_pk_bf16_f32 v58, v20, v21
    v_cvt_pk_bf16_f32 v59, v22, v23
    v_cvt_pk_bf16_f32 v60, v24, v25
    v_cvt_pk_bf16_f32 v61, v26, v27
    v_cvt_pk_bf16_f32 v62, v28, v29
    v_cvt_pk_bf16_f32 v63, v30, v31
    buffer_store_dwordx4 v[56:59], v2, s[20:23], s64 offen sc1
    s_mov_b64 exec, 0xff
    buffer_store_dwordx4 v[60:63], v2, s[20:23], s64 offen offset:1024 sc1
    s_mov_b64 exec, -1
L85_lnskip:
L82_lnjoin:
    s_waitcnt vmcnt(0)
    s_barrier
    s_cmp_lg_u32 s3, 0
    s_cbranch_scc1 L86_pub
    s_lshl_b32 s4, s2, 7
    s_add_u32 s4, s4, 131072
    s_add_u32 s4, s4, s99
    v_mov_b32 v1, s4
    v_mov_b32 v2, s100
    v_mov_b32 v3, s101
    s_mov_b64 exec, 1
    buffer_store_dwordx2 v[2:3], v1, s[88:91], 0 offen sc1
    s_mov_b64 exec, -1
L86_pub:
    s_load_dwordx4 s[64:67], s[0:1], 32
    s_and_b32 s68, s2, 7
    s_lshr_b32 s69, s2, 3
    s_and_b32 s70, s69, 3
    s_lshl_b32 s68, s68, 2
    s_add_u32 s68, s68, s70
    s_lshr_b32 s69, s69, 2
    s_waitcnt lgkmcnt(0)
    s_mul_i32 s6, s69, 294912
    s_add_u32 s7, s6, 4194304
    s_add_u32 s8, s28, s7
    s_addc_u32 s9, s29, 0
    s_and_b32 s9, s9, 0xffff
    s_mov_b32 s10, 0
    s_mov_b32 s11, 0x00020000
    s_sub_u32 s10, 2359296, s6
    s_mul_i32 s6, s68, 288
    s_add_u32 s12, s64, s6
    s_addc_u32 s13, s65, 0
    s_and_b32 s13, s13, 0xffff
    s_mov_b32 s14, 0
    s_mov_b32 s15, 0x00020000
    s_sub_u32 s14, 5308416, s6
    s_add_u32 s16, s66, s6
    s_addc_u32 s17, s67, 0
    s_and_b32 s17, s17, 0xffff
    s_mov_b32 s18, 0
    s_mov_b32 s19, 0x00020000
    s_sub_u32 s18, 5308416, s6
    s_add_u32 s20, s28, 16777216
    s_addc_u32 s21, s29, 0
    s_and_b32 s21, s21, 0xffff
    s_mov_b32 s22, 18874368
    s_mov_b32 s23, 0x00020000
    s_cmp_lg_u32 s3, 0
    s_cbranch_scc1 L87_polln
    s_mov_b32 s6, -1
    s_mov_b32 s7, 0
    s_mov_b64 exec, s[6:7]
    v_add_u32 v1, s59, v0
    v_lshlrev_b32 v1, 7, v1
    v_add_u32 v1, 131072, v1
    v_add_u32 v1, s99, v1
    s_mov_b32 s5, 0
L87_poll:
    buffer_load_dwordx2 v[2:3], v1, s[88:91], 0 offen sc1
    s_waitcnt vmcnt(0)
    v_cmp_ne_u64 vcc, s[100:101], v[2:3]
    s_add_u32 s5, s5, 1
    s_cmp_gt_u32 s5, 0x40000
    s_cbranch_scc1 L87_pollx
    s_cbranch_vccz L87_pollx
    s_sleep 1
    s_branch L87_poll
L87_pollx:
    s_mov_b64 exec, -1
L87_polln:
    s_barrier
    s_cmp_ge_u32 s3, 32
    s_cbranch_scc1 L88_ta
    s_add_u32 m0, s56, 0
    s_nop 0
    buffer_load_dwordx4 v160, s[32:35], s72 offen lds
    s_add_u32 s72, s72, s78
L88_ta:
    s_cmp_ge_u32 s3, 20
    s_cbranch_scc1 L89_ta
    s_add_u32 m0, s56, 12288
    s_nop 0
    buffer_load_dwordx4 v161, s[36:39], s73 offen lds
    s_add_u32 s73, s73, s79
L89_ta:
    s_cmp_ge_u32 s3, 8
    s_cbranch_scc1 L90_ta
    s_add_u32 m0, s56, 24576
    s_nop 0
    buffer_load_dwordx4 v162, s[40:43], s74 offen lds
    s_add_u32 s74, s74, s80
L90_ta:
    s_cmp_ge_u32 s3, 32
    s_cbranch_scc1 L91_ta
    s_add_u32 m0, s56, 69632
    s_nop 0
    buffer_load_dwordx4 v160, s[32:35], s72 offen lds
    s_add_u32 s72, s72, s78
L91_ta:
    s_cmp_ge_u32 s3, 20
    s_cbranch_scc1 L92_ta
    s_add_u32 m0, s56, 81920
    s_nop 0
    buffer_load_dwordx4 v161, s[36:39], s73 offen lds
    s_add_u32 s73, s73, s79
L92_ta:
    s_cmp_ge_u32 s3, 8
    s_cbranch_scc1 L93_ta
    s_add_u32 m0, s56, 94208
    s_nop 0
    buffer_load_dwordx4 v162, s[40:43], s74 offen lds
    s_add_u32 s74, s74, s80
L93_ta:
    s_cmp_ge_u32 s3, 8
    s_cbranch_scc1 L94_awa
    s_waitcnt vmcnt(3)
    s_branch L94_awb
L94_awa:
    s_waitcnt vmcnt(2)
L94_awb:
    s_barrier
    ds_read_b128 v[98:101], v154 offset:0
    ds_read_b128 v[102:105], v154 offset:2048
    ds_read_b128 v[106:109], v154 offset:4096
    ds_read_b128 v[110:113], v154 offset:6144
    ds_read_b64_tr_b16 v[130:131], v158 offset:0
    ds_read_b64_tr_b16 v[132:133], v158 offset:2304
    ds_read_b64_tr_b16 v[134:135], v158 offset:32
    ds_read_b64_tr_b16 v[136:137], v158 offset:2336
    ds_read_b64_tr_b16 v[138:139], v158 offset:64
    ds_read_b64_tr_b16 v[140:141], v158 offset:2368
    ds_read_b64_tr_b16 v[142:143], v158 offset:9216
    ds_read_b64_tr_b16 v[144:145], v158 offset:11520
    ds_read_b64_tr_b16 v[146:147], v158 offset:9248
    ds_read_b64_tr_b16 v[148:149], v158 offset:11552
    ds_read_b64_tr_b16 v[150:151], v158 offset:9280
    ds_read_b64_tr_b16 v[152:153], v158 offset:11584
    ds_read_b128 v[114:117], v155 offset:0
    ds_read_b128 v[118:121], v155 offset:2048
    ds_read_b128 v[122:125], v155 offset:4096
    ds_read_b128 v[126:129], v155 offset:6144
    s_waitcnt lgkmcnt(14)
    v_mfma_f32_16x16x32_bf16 v[2:5], v[130:133], v[98:101], 0
    v_mfma_f32_16x16x32_bf16 v[6:9], v[130:133], v[102:105], 0
    v_mfma_f32_16x16x32_bf16 v[10:13], v[130:133], v[106:109], 0
    v_mfma_f32_16x16x32_bf16 v[14:17], v[130:133], v[110:113], 0
    ds_read_b64_tr_b16 v[130:131], v158 offset:18432
    ds_read_b64_tr_b16 v[132:133], v158 offset:20736
    s_waitcnt lgkmcnt(14)
    v_mfma_f32_16x16x32_bf16 v[18:21], v[134:137], v[98:101], 0
    v_mfma_f32_16x16x32_bf16 v[22:25], v[134:137], v[102:105], 0
    v_mfma_f32_16x16x32_bf16 v[26:29], v[134:137], v[106:109], 0
    v_mfma_f32_16x16x32_bf16 v[30:33], v[134:137], v[110:113], 0
    ds_read_b64_tr_b16 v[134:135], v158 offset:18464
    ds_read_b64_tr_b16 v[136:137], v158 offset:20768
    s_waitcnt lgkmcnt(14)
    v_mfma_f32_16x16x32_bf16 v[34:37], v[138:141], v[98:101], 0
    v_mfma_f32_16x16x32_bf16 v[38:41], v[138:141], v[102:105], 0
    v_mfma_f32_16x16x32_bf16 v[42:45], v[138:141], v[106:109], 0
    v_mfma_f32_16x16x32_bf16 v[46:49], v[138:141], v[110:113], 0
    ds_read_b64_tr_b16 v[138:139], v158 offset:18496
    ds_read_b64_tr_b16 v[140:141], v158 offset:20800
    s_waitcnt lgkmcnt(14)
    v_mfma_f32_16x16x32_bf16 v[50:53], v[142:145], v[98:101], 0
    v_mfma_f32_16x16x32_bf16 v[54:57], v[142:145], v[102:105], 0
    v_mfma_f32_16x16x32_bf16 v[58:61], v[142:145], v[106:109], 0
    v_mfma_f32_16x16x32_bf16 v[62:65], v[142:145], v[110:113], 0
    ds_read_b64_tr_b16 v[142:143], v158 offset:27648
    ds_read_b64_tr_b16 v[144:145], v158 offset:29952
    s_waitcnt lgkmcnt(14)
    v_mfma_f32_16x16x32_bf16 v[66:69], v[146:149], v[98:101], 0
    v_mfma_f32_16x16x32_bf16 v[70:73], v[146:149], v[102:105], 0
    v_mfma_f32_16x16x32_bf16 v[74:77], v[146:149], v[106:109], 0
    v_mfma_f32_16x16x32_bf16 v[78:81], v[146:149], v[110:113], 0
    ds_read_b64_tr_b16 v[146:147], v158 offset:27680
    ds_read_b64_tr_b16 v[148:149], v158 offset:29984
    s_waitcnt lgkmcnt(14)
    v_mfma_f32_16x16x32_bf16 v[82:85], v[150:153], v[98:101], 0
    v_mfma_f32_16x16x32_bf16 v[86:89], v[150:153], v[102:105], 0
    v_mfma_f32_16x16x32_bf16 v[90:93], v[150:153], v[106:109], 0
    v_mfma_f32_16x16x32_bf16 v[94:97], v[150:153], v[110:113], 0
    ds_read_b64_tr_b16 v[150:151], v158 offset:27712
    ds_read_b64_tr_b16 v[152:153], v158 offset:30016
    s_waitcnt lgkmcnt(0)
    s_waitcnt vmcnt(0)
    s_barrier
    ds_read_b128 v[98:101], v156 offset:0
    ds_read_b128 v[102:105], v156 offset:2048
    ds_read_b128 v[106:109], v156 offset:4096
    ds_read_b128 v[110:113], v156 offset:6144
    s_waitcnt lgkmcnt(14)
    v_mfma_f32_16x16x32_bf16 v[2:5], v[130:133], v[114:117], v[2:5]
    v_mfma_f32_16x16x32_bf16 v[6:9], v[130:133], v[118:121], v[6:9]
    v_mfma_f32_16x16x32_bf16 v[10:13], v[130:133], v[122:125], v[10:13]
    v_mfma_f32_16x16x32_bf16 v[14:17], v[130:133], v[126:129], v[14:17]
    ds_read_b64_tr_b16 v[130:131], v159 offset:0
    ds_read_b64_tr_b16 v[132:133], v159 offset:2304
    s_add_u32 m0, s56, 0
    s_nop 0
    buffer_load_dwordx4 v160, s[32:35], s72 offen lds
    s_add_u32 s72, s72, s78
    s_waitcnt lgkmcnt(14)
    v_mfma_f32_16x16x32_bf16 v[18:21], v[134:137], v[114:117], v[18:21]
    v_mfma_f32_16x16x32_bf16 v[22:25], v[134:137], v[118:121], v[22:25]
    v_mfma_f32_16x16x32_bf16 v[26:29], v[134:137], v[122:125], v[26:29]
    v_mfma_f32_16x16x32_bf16 v[30:33], v[134:137], v[126:129], v[30:33]
    ds_read_b64_tr_b16 v[134:135], v159 offset:32
    ds_read_b64_tr_b16 v[136:137], v159 offset:2336
    s_add_u32 m0, s56, 12288
    s_nop 0
    buffer_load_dwordx4 v161, s[36:39], s73 offen lds
    s_add_u32 s73, s73, s79
    s_waitcnt lgkmcnt(14)
    v_mfma_f32_16x16x32_bf16 v[34:37], v[138:141], v[114:117], v[34:37]
    v_mfma_f32_16x16x32_bf16 v[38:41], v[138:141], v[118:121], v[38:41]
    v_mfma_f32_16x16x32_bf16 v[42:45], v[138:141], v[122:125], v[42:45]
    v_mfma_f32_16x16x32_bf16 v[46:49], v[138:141], v[126:129], v[46:49]
    ds_read_b64_tr_b16 v[138:139], v159 offset:64
    ds_read_b64_tr_b16 v[140:141], v159 offset:2368
    s_add_u32 m0, s56, 24576
    s_nop 0
    buffer_load_dwordx4 v162, s[40:43], s74 offen lds
    s_add_u32 s74, s74, s80
    s_waitcnt lgkmcnt(14)
    v_mfma_f32_16x16x32_bf16 v[50:53], v[142:145], v[114:117], v[50:53]
    v_mfma_f32_16x16x32_bf16 v[54:57], v[142:145], v[118:121], v[54:57]
    v_mfma_f32_16x16x32_bf16 v[58:61], v[142:145], v[122:125], v[58:61]
    v_mfma_f32_16x16x32_bf16 v[62:65], v[142:145], v[126:129], v[62:65]
    ds_read_b64_tr_b16 v[142:143], v159 offset:9216
    ds_read_b64_tr_b16 v[144:145], v159 offset:11520
    s_add_u32 m0, s56, 36864
    s_nop 0
    buffer_load_dwordx4 v163, s[44:47], s75 offen lds
    s_add_u32 s75, s75, s81
    s_waitcnt lgkmcnt(14)
    v_mfma_f32_16x16x32_bf16 v[66:69], v[146:149], v[114:117], v[66:69]
    v_mfma_f32_16x16x32_bf16 v[70:73], v[146:149], v[118:121], v[70:73]
    v_mfma_f32_16x16x32_bf16 v[74:77], v[146:149], v[122:125], v[74:77]
    v_mfma_f32_16x16x32_bf16 v[78:81], v[146:149], v[126:129], v[78:81]
    ds_read_b64_tr_b16 v[146:147], v159 offset:9248
    ds_read_b64_tr_b16 v[148:149], v159 offset:11552
    s_add_u32 m0, s56, 49152
    s_nop 0
    buffer_load_dwordx4 v164, s[48:51], s76 offen lds
    s_add_u32 s76, s76, s82
    s_waitcnt lgkmcnt(14)
    v_mfma_f32_16x16x32_bf16 v[82:85], v[150:153], v[114:117], v[82:85]
    v_mfma_f32_16x16x32_bf16 v[86:89], v[150:153], v[118:121], v[86:89]
    v_mfma_f32_16x16x32_bf16 v[90:93], v[150:153], v[122:125], v[90:93]
    v_mfma_f32_16x16x32_bf16 v[94:97], v[150:153], v[126:129], v[94:97]
    ds_read_b64_tr_b16 v[150:151], v159 offset:9280
    ds_read_b64_tr_b16 v[152:153], v159 offset:11584
    s_cmp_eq_u32 s57, 1
    s_cbranch_scc1 L96_d
    s_add_u32 m0, s56, 61440
    s_nop 0
    buffer_load_dwordx4 v165, s[52:55], s77 offen lds
    s_add_u32 s77, s77, s83
L96_d:
    ds_read_b128 v[114:117], v157 offset:0
    ds_read_b128 v[118:121], v157 offset:2048
    ds_read_b128 v[122:125], v157 offset:4096
    ds_read_b128 v[126:129], v157 offset:6144
    s_waitcnt lgkmcnt(14)
    v_mfma_f32_16x16x32_bf16 v[2:5], v[130:133], v[98:101], v[2:5]
    v_mfma_f32_16x16x32_bf16 v[6:9], v[130:133], v[102:105], v[6:9]
    v_mfma_f32_16x16x32_bf16 v[10:13], v[130:133], v[106:109], v[10:13]
    v_mfma_f32_16x16x32_bf16 v[14:17], v[130:133], v[110:113], v[14:17]
    ds_read_b64_tr_b16 v[130:131], v159 offset:18432
    ds_read_b64_tr_b16 v[132:133], v159 offset:20736
    s_waitcnt lgkmcnt(14)
    v_mfma_f32_16x16x32_bf16 v[18:21], v[134:137], v[98:101], v[18:21]
    v_mfma_f32_16x16x32_bf16 v[22:25], v[134:137], v[102:105], v[22:25]
    v_mfma_f32_16x16x32_bf16 v[26:29], v[134:137], v[106:109], v[26:29]
    v_mfma_f32_16x16x32_bf16 v[30:33], v[134:137], v[110:113], v[30:33]
    ds_read_b64_tr_b16 v[134:135], v159 offset:18464
    ds_read_b64_tr_b16 v[136:137], v159 offset:20768
    s_waitcnt lgkmcnt(14)
    v_mfma_f32_16x16x32_bf16 v[34:37], v[138:141], v[98:101], v[34:37]
    v_mfma_f32_16x16x32_bf16 v[38:41], v[138:141], v[102:105], v[38:41]
    v_mfma_f32_16x16x32_bf16 v[42:45], v[138:141], v[106:109], v[42:45]
    v_mfma_f32_16x16x32_bf16 v[46:49], v[138:141], v[110:113], v[46:49]
    ds_read_b64_tr_b16 v[138:139], v159 offset:18496
    ds_read_b64_tr_b16 v[140:141], v159 offset:20800
    s_waitcnt lgkmcnt(14)
    v_mfma_f32_16x16x32_bf16 v[50:53], v[142:145], v[98:101], v[50:53]
    v_mfma_f32_16x16x32_bf16 v[54:57], v[142:145], v[102:105], v[54:57]
    v_mfma_f32_16x16x32_bf16 v[58:61], v[142:145], v[106:109], v[58:61]
    v_mfma_f32_16x16x32_bf16 v[62:65], v[142:145], v[110:113], v[62:65]
    ds_read_b64_tr_b16 v[142:143], v159 offset:27648
    ds_read_b64_tr_b16 v[144:145], v159 offset:29952
    s_waitcnt lgkmcnt(14)
    v_mfma_f32_16x16x32_bf16 v[66:69], v[146:149], v[98:101], v[66:69]
    v_mfma_f32_16x16x32_bf16 v[70:73], v[146:149], v[102:105], v[70:73]
    v_mfma_f32_16x16x32_bf16 v[74:77], v[146:149], v[106:109], v[74:77]
    v_mfma_f32_16x16x32_bf16 v[78:81], v[146:149], v[110:113], v[78:81]
    ds_read_b64_tr_b16 v[146:147], v159 offset:27680
    ds_read_b64_tr_b16 v[148:149], v159 offset:29984
    s_waitcnt lgkmcnt(14)
    v_mfma_f32_16x16x32_bf16 v[82:85], v[150:153], v[98:101], v[82:85]
    v_mfma_f32_16x16x32_bf16 v[86:89], v[150:153], v[102:105], v[86:89]
    v_mfma_f32_16x16x32_bf16 v[90:93], v[150:153], v[106:109], v[90:93]
    v_mfma_f32_16x16x32_bf16 v[94:97], v[150:153], v[110:113], v[94:97]
    ds_read_b64_tr_b16 v[150:151], v159 offset:27712
    ds_read_b64_tr_b16 v[152:153], v159 offset:30016
    s_waitcnt lgkmcnt(0)
    s_waitcnt vmcnt(0)
    s_barrier
    ds_read_b128 v[98:101], v154 offset:0
    ds_read_b128 v[102:105], v154 offset:2048
    ds_read_b128 v[106:109], v154 offset:4096
    ds_read_b128 v[110:113], v154 offset:6144
    s_waitcnt lgkmcnt(14)
    v_mfma_f32_16x16x32_bf16 v[2:5], v[130:133], v[114:117], v[2:5]
    v_mfma_f32_16x16x32_bf16 v[6:9], v[130:133], v[118:121], v[6:9]
    v_mfma_f32_16x16x32_bf16 v[10:13], v[130:133], v[122:125], v[10:13]
    v_mfma_f32_16x16x32_bf16 v[14:17], v[130:133], v[126:129], v[14:17]
    ds_read_b64_tr_b16 v[130:131], v158 offset:0
    ds_read_b64_tr_b16 v[132:133], v158 offset:2304
    s_add_u32 m0, s56, 69632
    s_nop 0
    buffer_load_dwordx4 v160, s[32:35], s72 offen lds
    s_add_u32 s72, s72, s78
    s_waitcnt lgkmcnt(14)
    v_mfma_f32_16x16x32_bf16 v[18:21], v[134:137], v[114:117], v[18:21]
    v_mfma_f32_16x16x32_bf16 v[22:25], v[134:137], v[118:121], v[22:25]
    v_mfma_f32_16x16x32_bf16 v[26:29], v[134:137], v[122:125], v[26:29]
    v_mfma_f32_16x16x32_bf16 v[30:33], v[134:137], v[126:129], v[30:33]
    ds_read_b64_tr_b16 v[134:135], v158 offset:32
    ds_read_b64_tr_b16 v[136:137], v158 offset:2336
    s_add_u32 m0, s56, 81920
    s_nop 0
    buffer_load_dwordx4 v161, s[36:39], s73 offen lds
    s_add_u32 s73, s73, s79
    s_waitcnt lgkmcnt(14)
    v_mfma_f32_16x16x32_bf16 v[34:37], v[138:141], v[114:117], v[34:37]
    v_mfma_f32_16x16x32_bf16 v[38:41], v[138:141], v[118:121], v[38:41]
    v_mfma_f32_16x16x32_bf16 v[42:45], v[138:141], v[122:125], v[42:45]
    v_mfma_f32_16x16x32_bf16 v[46:49], v[138:141], v[126:129], v[46:49]
    ds_read_b64_tr_b16 v[138:139], v158 offset:64
    ds_read_b64_tr_b16 v[140:141], v158 offset:2368
    s_add_u32 m0, s56, 94208
    s_nop 0
    buffer_load_dwordx4 v162, s[40:43], s74 offen lds
    s_add_u32 s74, s74, s80
    s_waitcnt lgkmcnt(14)
    v_mfma_f32_16x16x32_bf16 v[50:53], v[142:145], v[114:117], v[50:53]
    v_mfma_f32_16x16x32_bf16 v[54:57], v[142:145], v[118:121], v[54:57]
    v_mfma_f32_16x16x32_bf16 v[58:61], v[142:145], v[122:125], v[58:61]
    v_mfma_f32_16x16x32_bf16 v[62:65], v[142:145], v[126:129], v[62:65]
    ds_read_b64_tr_b16 v[142:143], v158 offset:9216
    ds_read_b64_tr_b16 v[144:145], v158 offset:11520
    s_add_u32 m0, s56, 106496
    s_nop 0
    buffer_load_dwordx4 v163, s[44:47], s75 offen lds
    s_add_u32 s75, s75, s81
    s_waitcnt lgkmcnt(14)
    v_mfma_f32_16x16x32_bf16 v[66:69], v[146:149], v[114:117], v[66:69]
    v_mfma_f32_16x16x32_bf16 v[70:73], v[146:149], v[118:121], v[70:73]
    v_mfma_f32_16x16x32_bf16 v[74:77], v[146:149], v[122:125], v[74:77]
    v_mfma_f32_16x16x32_bf16 v[78:81], v[146:149], v[126:129], v[78:81]
    ds_read_b64_tr_b16 v[146:147], v158 offset:9248
    ds_read_b64_tr_b16 v[148:149], v158 offset:11552
    s_add_u32 m0, s56, 118784
    s_nop 0
    buffer_load_dwordx4 v164, s[48:51], s76 offen lds
    s_add_u32 s76, s76, s82
    s_waitcnt lgkmcnt(14)
    v_mfma_f32_16x16x32_bf16 v[82:85], v[150:153], v[114:117], v[82:85]
    v_mfma_f32_16x16x32_bf16 v[86:89], v[150:153], v[118:121], v[86:89]
    v_mfma_f32_16x16x32_bf16 v[90:93], v[150:153], v[122:125], v[90:93]
    v_mfma_f32_16x16x32_bf16 v[94:97], v[150:153], v[126:129], v[94:97]
    ds_read_b64_tr_b16 v[150:151], v158 offset:9280
    ds_read_b64_tr_b16 v[152:153], v158 offset:11584
    s_cmp_eq_u32 s57, 1
    s_cbranch_scc1 L97_d
    s_add_u32 m0, s56, 131072
    s_nop 0
    buffer_load_dwordx4 v165, s[52:55], s77 offen lds
    s_add_u32 s77, s77, s83
L97_d:
    ds_read_b128 v[114:117], v155 offset:0
    ds_read_b128 v[118:121], v155 offset:2048
    ds_read_b128 v[122:125], v155 offset:4096
    ds_read_b128 v[126:129], v155 offset:6144
    s_waitcnt lgkmcnt(14)
    v_mfma_f32_16x16x32_bf16 v[2:5], v[130:133], v[98:101], v[2:5]
    v_mfma_f32_16x16x32_bf16 v[6:9], v[130:133], v[102:105], v[6:9]
    v_mfma_f32_16x16x32_bf16 v[10:13], v[130:133], v[106:109], v[10:13]
    v_mfma_f32_16x16x32_bf16 v[14:17], v[130:133], v[110:113], v[14:17]
    ds_read_b64_tr_b16 v[130:131], v158 offset:18432
    ds_read_b64_tr_b16 v[132:133], v158 offset:20736
    s_waitcnt lgkmcnt(14)
    v_mfma_f32_16x16x32_bf16 v[18:21], v[134:137], v[98:101], v[18:21]
    v_mfma_f32_16x16x32_bf16 v[22:25], v[134:137], v[102:105], v[22:25]
    v_mfma_f32_16x16x32_bf16 v[26:29], v[134:137], v[106:109], v[26:29]
    v_mfma_f32_16x16x32_bf16 v[30:33], v[134:137], v[110:113], v[30:33]
    ds_read_b64_tr_b16 v[134:135], v158 offset:18464
    ds_read_b64_tr_b16 v[136:137], v158 offset:20768
    s_waitcnt lgkmcnt(14)
    v_mfma_f32_16x16x32_bf16 v[34:37], v[138:141], v[98:101], v[34:37]
    v_mfma_f32_16x16x32_bf16 v[38:41], v[138:141], v[102:105], v[38:41]
    v_mfma_f32_16x16x32_bf16 v[42:45], v[138:141], v[106:109], v[42:45]
    v_mfma_f32_16x16x32_bf16 v[46:49], v[138:141], v[110:113], v[46:49]
    ds_read_b64_tr_b16 v[138:139], v158 offset:18496
    ds_read_b64_tr_b16 v[140:141], v158 offset:20800
    s_waitcnt lgkmcnt(14)
    v_mfma_f32_16x16x32_bf16 v[50:53], v[142:145], v[98:101], v[50:53]
    v_mfma_f32_16x16x32_bf16 v[54:57], v[142:145], v[102:105], v[54:57]
    v_mfma_f32_16x16x32_bf16 v[58:61], v[142:145], v[106:109], v[58:61]
    v_mfma_f32_16x16x32_bf16 v[62:65], v[142:145], v[110:113], v[62:65]
    ds_read_b64_tr_b16 v[142:143], v158 offset:27648
    ds_read_b64_tr_b16 v[144:145], v158 offset:29952
    s_waitcnt lgkmcnt(14)
    v_mfma_f32_16x16x32_bf16 v[66:69], v[146:149], v[98:101], v[66:69]
    v_mfma_f32_16x16x32_bf16 v[70:73], v[146:149], v[102:105], v[70:73]
    v_mfma_f32_16x16x32_bf16 v[74:77], v[146:149], v[106:109], v[74:77]
    v_mfma_f32_16x16x32_bf16 v[78:81], v[146:149], v[110:113], v[78:81]
    ds_read_b64_tr_b16 v[146:147], v158 offset:27680
    ds_read_b64_tr_b16 v[148:149], v158 offset:29984
    s_waitcnt lgkmcnt(14)
    v_mfma_f32_16x16x32_bf16 v[82:85], v[150:153], v[98:101], v[82:85]
    v_mfma_f32_16x16x32_bf16 v[86:89], v[150:153], v[102:105], v[86:89]
    v_mfma_f32_16x16x32_bf16 v[90:93], v[150:153], v[106:109], v[90:93]
    v_mfma_f32_16x16x32_bf16 v[94:97], v[150:153], v[110:113], v[94:97]
    ds_read_b64_tr_b16 v[150:151], v158 offset:27712
    ds_read_b64_tr_b16 v[152:153], v158 offset:30016
    s_waitcnt lgkmcnt(0)
    s_waitcnt vmcnt(0)
    s_barrier
    ds_read_b128 v[98:101], v156 offset:0
    ds_read_b128 v[102:105], v156 offset:2048
    ds_read_b128 v[106:109], v156 offset:4096
    ds_read_b128 v[110:113], v156 offset:6144
    s_waitcnt lgkmcnt(14)
    v_mfma_f32_16x16x32_bf16 v[2:5], v[130:133], v[114:117], v[2:5]
    v_mfma_f32_16x16x32_bf16 v[6:9], v[130:133], v[118:121], v[6:9]
    v_mfma_f32_16x16x32_bf16 v[10:13], v[130:133], v[122:125], v[10:13]
    v_mfma_f32_16x16x32_bf16 v[14:17], v[130:133], v[126:129], v[14:17]
    ds_read_b64_tr_b16 v[130:131], v159 offset:0
    ds_read_b64_tr_b16 v[132:133], v159 offset:2304
    s_add_u32 m0, s56, 0
    s_nop 0
    buffer_load_dwordx4 v160, s[32:35], s72 offen lds
    s_add_u32 s72, s72, s78
    s_waitcnt lgkmcnt(14)
    v_mfma_f32_16x16x32_bf16 v[18:21], v[134:137], v[114:117], v[18:21]
    v_mfma_f32_16x16x32_bf16 v[22:25], v[134:137], v[118:121], v[22:25]
    v_mfma_f32_16x16x32_bf16 v[26:29], v[134:137], v[122:125], v[26:29]
    v_mfma_f32_16x16x32_bf16 v[30:33], v[134:137], v[126:129], v[30:33]
    ds_read_b64_tr_b16 v[134:135], v159 offset:32
    ds_read_b64_tr_b16 v[136:137], v159 offset:2336
    s_add_u32 m0, s56, 12288
    s_nop 0
    buffer_load_dwordx4 v161, s[36:39], s73 offen lds
    s_add_u32 s73, s73, s79
    s_waitcnt lgkmcnt(14)
    v_mfma_f32_16x16x32_bf16 v[34:37], v[138:141], v[114:117], v[34:37]
    v_mfma_f32_16x16x32_bf16 v[38:41], v[138:141], v[118:121], v[38:41]
    v_mfma_f32_16x16x32_bf16 v[42:45], v[138:141], v[122:125], v[42:45]
    v_mfma_f32_16x16x32_bf16 v[46:49], v[138:141], v[126:129], v[46:49]
    ds_read_b64_tr_b16 v[138:139], v159 offset:64
    ds_read_b64_tr_b16 v[140:141], v159 offset:2368
    s_add_u32 m0, s56, 24576
    s_nop 0
    buffer_load_dwordx4 v162, s[40:43], s74 offen lds
    s_add_u32 s74, s74, s80
    s_waitcnt lgkmcnt(14)
    v_mfma_f32_16x16x32_bf16 v[50:53], v[142:145], v[114:117], v[50:53]
    v_mfma_f32_16x16x32_bf16 v[54:57], v[142:145], v[118:121], v[54:57]
    v_mfma_f32_16x16x32_bf16 v[58:61], v[142:145], v[122:125], v[58:61]
    v_mfma_f32_16x16x32_bf16 v[62:65], v[142:145], v[126:129], v[62:65]
    ds_read_b64_tr_b16 v[142:143], v159 offset:9216
    ds_read_b64_tr_b16 v[144:145], v159 offset:11520
    s_add_u32 m0, s56, 36864
    s_nop 0
    buffer_load_dwordx4 v163, s[44:47], s75 offen lds
    s_add_u32 s75, s75, s81
    s_waitcnt lgkmcnt(14)
    v_mfma_f32_16x16x32_bf16 v[66:69], v[146:149], v[114:117], v[66:69]
    v_mfma_f32_16x16x32_bf16 v[70:73], v[146:149], v[118:121], v[70:73]
    v_mfma_f32_16x16x32_bf16 v[74:77], v[146:149], v[122:125], v[74:77]
    v_mfma_f32_16x16x32_bf16 v[78:81], v[146:149], v[126:129], v[78:81]
    ds_read_b64_tr_b16 v[146:147], v159 offset:9248
    ds_read_b64_tr_b16 v[148:149], v159 offset:11552
    s_add_u32 m0, s56, 49152
    s_nop 0
    buffer_load_dwordx4 v164, s[48:51], s76 offen lds
    s_add_u32 s76, s76, s82
    s_waitcnt lgkmcnt(14)
    v_mfma_f32_16x16x32_bf16 v[82:85], v[150:153], v[114:117], v[82:85]
    v_mfma_f32_16x16x32_bf16 v[86:89], v[150:153], v[118:121], v[86:89]
    v_mfma_f32_16x16x32_bf16 v[90:93], v[150:153], v[122:125], v[90:93]
    v_mfma_f32_16x16x32_bf16 v[94:97], v[150:153], v[126:129], v[94:97]
    ds_read_b64_tr_b16 v[150:151], v159 offset:9280
    ds_read_b64_tr_b16 v[152:153], v159 offset:11584
    s_cmp_eq_u32 s57, 1
    s_cbranch_scc1 L98_d
    s_add_u32 m0, s56, 61440
    s_nop 0
    buffer_load_dwordx4 v165, s[52:55], s77 offen lds
    s_add_u32 s77, s77, s83
L98_d:
    ds_read_b128 v[114:117], v157 offset:0
    ds_read_b128 v[118:121], v157 offset:2048
    ds_read_b128 v[122:125], v157 offset:4096
    ds_read_b128 v[126:129], v157 offset:6144
    s_waitcnt lgkmcnt(14)
    v_mfma_f32_16x16x32_bf16 v[2:5], v[130:133], v[98:101], v[2:5]
    v_mfma_f32_16x16x32_bf16 v[6:9], v[130:133], v[102:105], v[6:9]
    v_mfma_f32_16x16x32_bf16 v[10:13], v[130:133], v[106:109], v[10:13]
    v_mfma_f32_16x16x32_bf16 v[14:17], v[130:133], v[110:113], v[14:17]
    ds_read_b64_tr_b16 v[130:131], v159 offset:18432
    ds_read_b64_tr_b16 v[132:133], v159 offset:20736
    s_waitcnt lgkmcnt(14)
    v_mfma_f32_16x16x32_bf16 v[18:21], v[134:137], v[98:101], v[18:21]
    v_mfma_f32_16x16x32_bf16 v[22:25], v[134:137], v[102:105], v[22:25]
    v_mfma_f32_16x16x32_bf16 v[26:29], v[134:137], v[106:109], v[26:29]
    v_mfma_f32_16x16x32_bf16 v[30:33], v[134:137], v[110:113], v[30:33]
    ds_read_b64_tr_b16 v[134:135], v159 offset:18464
    ds_read_b64_tr_b16 v[136:137], v159 offset:20768
    s_waitcnt lgkmcnt(14)
    v_mfma_f32_16x16x32_bf16 v[34:37], v[138:141], v[98:101], v[34:37]
    v_mfma_f32_16x16x32_bf16 v[38:41], v[138:141], v[102:105], v[38:41]
    v_mfma_f32_16x16x32_bf16 v[42:45], v[138:141], v[106:109], v[42:45]
    v_mfma_f32_16x16x32_bf16 v[46:49], v[138:141], v[110:113], v[46:49]
    ds_read_b64_tr_b16 v[138:139], v159 offset:18496
    ds_read_b64_tr_b16 v[140:141], v159 offset:20800
    s_waitcnt lgkmcnt(14)
    v_mfma_f32_16x16x32_bf16 v[50:53], v[142:145], v[98:101], v[50:53]
    v_mfma_f32_16x16x32_bf16 v[54:57], v[142:145], v[102:105], v[54:57]
    v_mfma_f32_16x16x32_bf16 v[58:61], v[142:145], v[106:109], v[58:61]
    v_mfma_f32_16x16x32_bf16 v[62:65], v[142:145], v[110:113], v[62:65]
    ds_read_b64_tr_b16 v[142:143], v159 offset:27648
    ds_read_b64_tr_b16 v[144:145], v159 offset:29952
    s_waitcnt lgkmcnt(14)
    v_mfma_f32_16x16x32_bf16 v[66:69], v[146:149], v[98:101], v[66:69]
    v_mfma_f32_16x16x32_bf16 v[70:73], v[146:149], v[102:105], v[70:73]
    v_mfma_f32_16x16x32_bf16 v[74:77], v[146:149], v[106:109], v[74:77]
    v_mfma_f32_16x16x32_bf16 v[78:81], v[146:149], v[110:113], v[78:81]
    ds_read_b64_tr_b16 v[146:147], v159 offset:27680
    ds_read_b64_tr_b16 v[148:149], v159 offset:29984
    s_waitcnt lgkmcnt(14)
    v_mfma_f32_16x16x32_bf16 v[82:85], v[150:153], v[98:101], v[82:85]
    v_mfma_f32_16x16x32_bf16 v[86:89], v[150:153], v[102:105], v[86:89]
    v_mfma_f32_16x16x32_bf16 v[90:93], v[150:153], v[106:109], v[90:93]
    v_mfma_f32_16x16x32_bf16 v[94:97], v[150:153], v[110:113], v[94:97]
    ds_read_b64_tr_b16 v[150:151], v159 offset:27712
    ds_read_b64_tr_b16 v[152:153], v159 offset:30016
    s_waitcnt lgkmcnt(0)
    s_waitcnt vmcnt(0)
    s_barrier
    ds_read_b128 v[98:101], v154 offset:0
    ds_read_b128 v[102:105], v154 offset:2048
    ds_read_b128 v[106:109], v154 offset:4096
    ds_read_b128 v[110:113], v154 offset:6144
    s_waitcnt lgkmcnt(14)
    v_mfma_f32_16x16x32_bf16 v[2:5], v[130:133], v[114:117], v[2:5]
    v_mfma_f32_16x16x32_bf16 v[6:9], v[130:133], v[118:121], v[6:9]
    v_mfma_f32_16x16x32_bf16 v[10:13], v[130:133], v[122:125], v[10:13]
    v_mfma_f32_16x16x32_bf16 v[14:17], v[130:133], v[126:129], v[14:17]
    ds_read_b64_tr_b16 v[130:131], v158 offset:0
    ds_read_b64_tr_b16 v[132:133], v158 offset:2304
    s_add_u32 m0, s56, 69632
    s_nop 0
    buffer_load_dwordx4 v160, s[32:35], s72 offen lds
    s_add_u32 s72, s72, s78
    s_waitcnt lgkmcnt(14)
    v_mfma_f32_16x16x32_bf16 v[18:21], v[134:137], v[114:117], v[18:21]
    v_mfma_f32_16x16x32_bf16 v[22:25], v[134:137], v[118:121], v[22:25]
    v_mfma_f32_16x16x32_bf16 v[26:29], v[134:137], v[122:125], v[26:29]
    v_mfma_f32_16x16x32_bf16 v[30:33], v[134:137], v[126:129], v[30:33]
    ds_read_b64_tr_b16 v[134:135], v158 offset:32
    ds_read_b64_tr_b16 v[136:137], v158 offset:2336
    s_add_u32 m0, s56, 81920
    s_nop 0
    buffer_load_dwordx4 v161, s[36:39], s73 offen lds
    s_add_u32 s73, s73, s79
    s_waitcnt lgkmcnt(14)
    v_mfma_f32_16x16x32_bf16 v[34:37], v[138:141], v[114:117], v[34:37]
    v_mfma_f32_16x16x32_bf16 v[38:41], v[138:141], v[118:121], v[38:41]
    v_mfma_f32_16x16x32_bf16 v[42:45], v[138:141], v[122:125], v[42:45]
    v_mfma_f32_16x16x32_bf16 v[46:49], v[138:141], v[126:129], v[46:49]
    ds_read_b64_tr_b16 v[138:139], v158 offset:64
    ds_read_b64_tr_b16 v[140:141], v158 offset:2368
    s_add_u32 m0, s56, 94208
    s_nop 0
    buffer_load_dwordx4 v162, s[40:43], s74 offen lds
    s_add_u32 s74, s74, s80
    s_waitcnt lgkmcnt(14)
    v_mfma_f32_16x16x32_bf16 v[50:53], v[142:145], v[114:117], v[50:53]
    v_mfma_f32_16x16x32_bf16 v[54:57], v[142:145], v[118:121], v[54:57]
    v_mfma_f32_16x16x32_bf16 v[58:61], v[142:145], v[122:125], v[58:61]
    v_mfma_f32_16x16x32_bf16 v[62:65], v[142:145], v[126:129], v[62:65]
    ds_read_b64_tr_b16 v[142:143], v158 offset:9216
    ds_read_b64_tr_b16 v[144:145], v158 offset:11520
    s_add_u32 m0, s56, 106496
    s_nop 0
    buffer_load_dwordx4 v163, s[44:47], s75 offen lds
    s_add_u32 s75, s75, s81
    s_waitcnt lgkmcnt(14)
    v_mfma_f32_16x16x32_bf16 v[66:69], v[146:149], v[114:117], v[66:69]
    v_mfma_f32_16x16x32_bf16 v[70:73], v[146:149], v[118:121], v[70:73]
    v_mfma_f32_16x16x32_bf16 v[74:77], v[146:149], v[122:125], v[74:77]
    v_mfma_f32_16x16x32_bf16 v[78:81], v[146:149], v[126:129], v[78:81]
    ds_read_b64_tr_b16 v[146:147], v158 offset:9248
    ds_read_b64_tr_b16 v[148:149], v158 offset:11552
    s_add_u32 m0, s56, 118784
    s_nop 0
    buffer_load_dwordx4 v164, s[48:51], s76 offen lds
    s_add_u32 s76, s76, s82
    s_waitcnt lgkmcnt(14)
    v_mfma_f32_16x16x32_bf16 v[82:85], v[150:153], v[114:117], v[82:85]
    v_mfma_f32_16x16x32_bf16 v[86:89], v[150:153], v[118:121], v[86:89]
    v_mfma_f32_16x16x32_bf16 v[90:93], v[150:153], v[122:125], v[90:93]
    v_mfma_f32_16x16x32_bf16 v[94:97], v[150:153], v[126:129], v[94:97]
    ds_read_b64_tr_b16 v[150:151], v158 offset:9280
    ds_read_b64_tr_b16 v[152:153], v158 offset:11584
    s_cmp_eq_u32 s57, 1
    s_cbranch_scc1 L99_d
    s_add_u32 m0, s56, 131072
    s_nop 0
    buffer_load_dwordx4 v165, s[52:55], s77 offen lds
    s_add_u32 s77, s77, s83
L99_d:
    ds_read_b128 v[114:117], v155 offset:0
    ds_read_b128 v[118:121], v155 offset:2048
    ds_read_b128 v[122:125], v155 offset:4096
    ds_read_b128 v[126:129], v155 offset:6144
    s_waitcnt lgkmcnt(14)
    v_mfma_f32_16x16x32_bf16 v[2:5], v[130:133], v[98:101], v[2:5]
    v_mfma_f32_16x16x32_bf16 v[6:9], v[130:133], v[102:105], v[6:9]
    v_mfma_f32_16x16x32_bf16 v[10:13], v[130:133], v[106:109], v[10:13]
    v_mfma_f32_16x16x32_bf16 v[14:17], v[130:133], v[110:113], v[14:17]
    ds_read_b64_tr_b16 v[130:131], v158 offset:18432
    ds_read_b64_tr_b16 v[132:133], v158 offset:20736
    s_waitcnt lgkmcnt(14)
    v_mfma_f32_16x16x32_bf16 v[18:21], v[134:137], v[98:101], v[18:21]
    v_mfma_f32_16x16x32_bf16 v[22:25], v[134:137], v[102:105], v[22:25]
    v_mfma_f32_16x16x32_bf16 v[26:29], v[134:137], v[106:109], v[26:29]
    v_mfma_f32_16x16x32_bf16 v[30:33], v[134:137], v[110:113], v[30:33]
    ds_read_b64_tr_b16 v[134:135], v158 offset:18464
    ds_read_b64_tr_b16 v[136:137], v158 offset:20768
    s_waitcnt lgkmcnt(14)
    v_mfma_f32_16x16x32_bf16 v[34:37], v[138:141], v[98:101], v[34:37]
    v_mfma_f32_16x16x32_bf16 v[38:41], v[138:141], v[102:105], v[38:41]
    v_mfma_f32_16x16x32_bf16 v[42:45], v[138:141], v[106:109], v[42:45]
    v_mfma_f32_16x16x32_bf16 v[46:49], v[138:141], v[110:113], v[46:49]
    ds_read_b64_tr_b16 v[138:139], v158 offset:18496
    ds_read_b64_tr_b16 v[140:141], v158 offset:20800
    s_waitcnt lgkmcnt(14)
    v_mfma_f32_16x16x32_bf16 v[50:53], v[142:145], v[98:101], v[50:53]
    v_mfma_f32_16x16x32_bf16 v[54:57], v[142:145], v[102:105], v[54:57]
    v_mfma_f32_16x16x32_bf16 v[58:61], v[142:145], v[106:109], v[58:61]
    v_mfma_f32_16x16x32_bf16 v[62:65], v[142:145], v[110:113], v[62:65]
    ds_read_b64_tr_b16 v[142:143], v158 offset:27648
    ds_read_b64_tr_b16 v[144:145], v158 offset:29952
    s_waitcnt lgkmcnt(14)
    v_mfma_f32_16x16x32_bf16 v[66:69], v[146:149], v[98:101], v[66:69]
    v_mfma_f32_16x16x32_bf16 v[70:73], v[146:149], v[102:105], v[70:73]
    v_mfma_f32_16x16x32_bf16 v[74:77], v[146:149], v[106:109], v[74:77]
    v_mfma_f32_16x16x32_bf16 v[78:81], v[146:149], v[110:113], v[78:81]
    ds_read_b64_tr_b16 v[146:147], v158 offset:27680
    ds_read_b64_tr_b16 v[148:149], v158 offset:29984
    s_waitcnt lgkmcnt(14)
    v_mfma_f32_16x16x32_bf16 v[82:85], v[150:153], v[98:101], v[82:85]
    v_mfma_f32_16x16x32_bf16 v[86:89], v[150:153], v[102:105], v[86:89]
    v_mfma_f32_16x16x32_bf16 v[90:93], v[150:153], v[106:109], v[90:93]
    v_mfma_f32_16x16x32_bf16 v[94:97], v[150:153], v[110:113], v[94:97]
    ds_read_b64_tr_b16 v[150:151], v158 offset:27712
    ds_read_b64_tr_b16 v[152:153], v158 offset:30016
    s_waitcnt lgkmcnt(0)
    s_waitcnt vmcnt(0)
    s_barrier
    ds_read_b128 v[98:101], v156 offset:0
    ds_read_b128 v[102:105], v156 offset:2048
    ds_read_b128 v[106:109], v156 offset:4096
    ds_read_b128 v[110:113], v156 offset:6144
    s_waitcnt lgkmcnt(14)
    v_mfma_f32_16x16x32_bf16 v[2:5], v[130:133], v[114:117], v[2:5]
    v_mfma_f32_16x16x32_bf16 v[6:9], v[130:133], v[118:121], v[6:9]
    v_mfma_f32_16x16x32_bf16 v[10:13], v[130:133], v[122:125], v[10:13]
    v_mfma_f32_16x16x32_bf16 v[14:17], v[130:133], v[126:129], v[14:17]
    ds_read_b64_tr_b16 v[130:131], v159 offset:0
    ds_read_b64_tr_b16 v[132:133], v159 offset:2304
    s_add_u32 m0, s56, 0
    s_nop 0
    buffer_load_dwordx4 v160, s[32:35], s72 offen lds
    s_add_u32 s72, s72, s78
    s_waitcnt lgkmcnt(14)
    v_mfma_f32_16x16x32_bf16 v[18:21], v[134:137], v[114:117], v[18:21]
    v_mfma_f32_16x16x32_bf16 v[22:25], v[134:137], v[118:121], v[22:25]
    v_mfma_f32_16x16x32_bf16 v[26:29], v[134:137], v[122:125], v[26:29]
    v_mfma_f32_16x16x32_bf16 v[30:33], v[134:137], v[126:129], v[30:33]
    ds_read_b64_tr_b16 v[134:135], v159 offset:32
    ds_read_b64_tr_b16 v[136:137], v159 offset:2336
    s_add_u32 m0, s56, 12288
    s_nop 0
    buffer_load_dwordx4 v161, s[36:39], s73 offen lds
    s_add_u32 s73, s73, s79
    s_waitcnt lgkmcnt(14)
    v_mfma_f32_16x16x32_bf16 v[34:37], v[138:141], v[114:117], v[34:37]
    v_mfma_f32_16x16x32_bf16 v[38:41], v[138:141], v[118:121], v[38:41]
    v_mfma_f32_16x16x32_bf16 v[42:45], v[138:141], v[122:125], v[42:45]
    v_mfma_f32_16x16x32_bf16 v[46:49], v[138:141], v[126:129], v[46:49]
    ds_read_b64_tr_b16 v[138:139], v159 offset:64
    ds_read_b64_tr_b16 v[140:141], v159 offset:2368
    s_add_u32 m0, s56, 24576
    s_nop 0
    buffer_load_dwordx4 v162, s[40:43], s74 offen lds
    s_add_u32 s74, s74, s80
    s_waitcnt lgkmcnt(14)
    v_mfma_f32_16x16x32_bf16 v[50:53], v[142:145], v[114:117], v[50:53]
    v_mfma_f32_16x16x32_bf16 v[54:57], v[142:145], v[118:121], v[54:57]
    v_mfma_f32_16x16x32_bf16 v[58:61], v[142:145], v[122:125], v[58:61]
    v_mfma_f32_16x16x32_bf16 v[62:65], v[142:145], v[126:129], v[62:65]
    ds_read_b64_tr_b16 v[142:143], v159 offset:9216
    ds_read_b64_tr_b16 v[144:145], v159 offset:11520
    s_add_u32 m0, s56, 36864
    s_nop 0
    buffer_load_dwordx4 v163, s[44:47], s75 offen lds
    s_add_u32 s75, s75, s81
    s_waitcnt lgkmcnt(14)
    v_mfma_f32_16x16x32_bf16 v[66:69], v[146:149], v[114:117], v[66:69]
    v_mfma_f32_16x16x32_bf16 v[70:73], v[146:149], v[118:121], v[70:73]
    v_mfma_f32_16x16x32_bf16 v[74:77], v[146:149], v[122:125], v[74:77]
    v_mfma_f32_16x16x32_bf16 v[78:81], v[146:149], v[126:129], v[78:81]
    ds_read_b64_tr_b16 v[146:147], v159 offset:9248
    ds_read_b64_tr_b16 v[148:149], v159 offset:11552
    s_add_u32 m0, s56, 49152
    s_nop 0
    buffer_load_dwordx4 v164, s[48:51], s76 offen lds
    s_add_u32 s76, s76, s82
    s_waitcnt lgkmcnt(14)
    v_mfma_f32_16x16x32_bf16 v[82:85], v[150:153], v[114:117], v[82:85]
    v_mfma_f32_16x16x32_bf16 v[86:89], v[150:153], v[118:121], v[86:89]
    v_mfma_f32_16x16x32_bf16 v[90:93], v[150:153], v[122:125], v[90:93]
    v_mfma_f32_16x16x32_bf16 v[94:97], v[150:153], v[126:129], v[94:97]
    ds_read_b64_tr_b16 v[150:151], v159 offset:9280
    ds_read_b64_tr_b16 v[152:153], v159 offset:11584
    s_cmp_eq_u32 s57, 1
    s_cbranch_scc1 L100_d
    s_add_u32 m0, s56, 61440
    s_nop 0
    buffer_load_dwordx4 v165, s[52:55], s77 offen lds
    s_add_u32 s77, s77, s83
L100_d:
    ds_read_b128 v[114:117], v157 offset:0
    ds_read_b128 v[118:121], v157 offset:2048
    ds_read_b128 v[122:125], v157 offset:4096
    ds_read_b128 v[126:129], v157 offset:6144
    s_waitcnt lgkmcnt(14)
    v_mfma_f32_16x16x32_bf16 v[2:5], v[130:133], v[98:101], v[2:5]
    v_mfma_f32_16x16x32_bf16 v[6:9], v[130:133], v[102:105], v[6:9]
    v_mfma_f32_16x16x32_bf16 v[10:13], v[130:133], v[106:109], v[10:13]
    v_mfma_f32_16x16x32_bf16 v[14:17], v[130:133], v[110:113], v[14:17]
    ds_read_b64_tr_b16 v[130:131], v159 offset:18432
    ds_read_b64_tr_b16 v[132:133], v159 offset:20736
    s_waitcnt lgkmcnt(14)
    v_mfma_f32_16x16x32_bf16 v[18:21], v[134:137], v[98:101], v[18:21]
    v_mfma_f32_16x16x32_bf16 v[22:25], v[134:137], v[102:105], v[22:25]
    v_mfma_f32_16x16x32_bf16 v[26:29], v[134:137], v[106:109], v[26:29]
    v_mfma_f32_16x16x32_bf16 v[30:33], v[134:137], v[110:113], v[30:33]
    ds_read_b64_tr_b16 v[134:135], v159 offset:18464
    ds_read_b64_tr_b16 v[136:137], v159 offset:20768
    s_waitcnt lgkmcnt(14)
    v_mfma_f32_16x16x32_bf16 v[34:37], v[138:141], v[98:101], v[34:37]
    v_mfma_f32_16x16x32_bf16 v[38:41], v[138:141], v[102:105], v[38:41]
    v_mfma_f32_16x16x32_bf16 v[42:45], v[138:141], v[106:109], v[42:45]
    v_mfma_f32_16x16x32_bf16 v[46:49], v[138:141], v[110:113], v[46:49]
    ds_read_b64_tr_b16 v[138:139], v159 offset:18496
    ds_read_b64_tr_b16 v[140:141], v159 offset:20800
    s_waitcnt lgkmcnt(14)
    v_mfma_f32_16x16x32_bf16 v[50:53], v[142:145], v[98:101], v[50:53]
    v_mfma_f32_16x16x32_bf16 v[54:57], v[142:145], v[102:105], v[54:57]
    v_mfma_f32_16x16x32_bf16 v[58:61], v[142:145], v[106:109], v[58:61]
    v_mfma_f32_16x16x32_bf16 v[62:65], v[142:145], v[110:113], v[62:65]
    ds_read_b64_tr_b16 v[142:143], v159 offset:27648
    ds_read_b64_tr_b16 v[144:145], v159 offset:29952
    s_waitcnt lgkmcnt(14)
    v_mfma_f32_16x16x32_bf16 v[66:69], v[146:149], v[98:101], v[66:69]
    v_mfma_f32_16x16x32_bf16 v[70:73], v[146:149], v[102:105], v[70:73]
    v_mfma_f32_16x16x32_bf16 v[74:77], v[146:149], v[106:109], v[74:77]
    v_mfma_f32_16x16x32_bf16 v[78:81], v[146:149], v[110:113], v[78:81]
    ds_read_b64_tr_b16 v[146:147], v159 offset:27680
    ds_read_b64_tr_b16 v[148:149], v159 offset:29984
    s_waitcnt lgkmcnt(14)
    v_mfma_f32_16x16x32_bf16 v[82:85], v[150:153], v[98:101], v[82:85]
    v_mfma_f32_16x16x32_bf16 v[86:89], v[150:153], v[102:105], v[86:89]
    v_mfma_f32_16x16x32_bf16 v[90:93], v[150:153], v[106:109], v[90:93]
    v_mfma_f32_16x16x32_bf16 v[94:97], v[150:153], v[110:113], v[94:97]
    ds_read_b64_tr_b16 v[150:151], v159 offset:27712
    ds_read_b64_tr_b16 v[152:153], v159 offset:30016
    s_waitcnt lgkmcnt(0)
    s_waitcnt vmcnt(0)
    s_barrier
    ds_read_b128 v[98:101], v154 offset:0
    ds_read_b128 v[102:105], v154 offset:2048
    ds_read_b128 v[106:109], v154 offset:4096
    ds_read_b128 v[110:113], v154 offset:6144
    s_waitcnt lgkmcnt(14)
    v_mfma_f32_16x16x32_bf16 v[2:5], v[130:133], v[114:117], v[2:5]
    v_mfma_f32_16x16x32_bf16 v[6:9], v[130:133], v[118:121], v[6:9]
    v_mfma_f32_16x16x32_bf16 v[10:13], v[130:133], v[122:125], v[10:13]
    v_mfma_f32_16x16x32_bf16 v[14:17], v[130:133], v[126:129], v[14:17]
    ds_read_b64_tr_b16 v[130:131], v158 offset:0
    ds_read_b64_tr_b16 v[132:133], v158 offset:2304
    s_add_u32 m0, s56, 69632
    s_nop 0
    buffer_load_dwordx4 v160, s[32:35], s72 offen lds
    s_add_u32 s72, s72, s78
    s_waitcnt lgkmcnt(14)
    v_mfma_f32_16x16x32_bf16 v[18:21], v[134:137], v[114:117], v[18:21]
    v_mfma_f32_16x16x32_bf16 v[22:25], v[134:137], v[118:121], v[22:25]
    v_mfma_f32_16x16x32_bf16 v[26:29], v[134:137], v[122:125], v[26:29]
    v_mfma_f32_16x16x32_bf16 v[30:33], v[134:137], v[126:129], v[30:33]
    ds_read_b64_tr_b16 v[134:135], v158 offset:32
    ds_read_b64_tr_b16 v[136:137], v158 offset:2336
    s_add_u32 m0, s56, 81920
    s_nop 0
    buffer_load_dwordx4 v161, s[36:39], s73 offen lds
    s_add_u32 s73, s73, s79
    s_waitcnt lgkmcnt(14)
    v_mfma_f32_16x16x32_bf16 v[34:37], v[138:141], v[114:117], v[34:37]
    v_mfma_f32_16x16x32_bf16 v[38:41], v[138:141], v[118:121], v[38:41]
    v_mfma_f32_16x16x32_bf16 v[42:45], v[138:141], v[122:125], v[42:45]
    v_mfma_f32_16x16x32_bf16 v[46:49], v[138:141], v[126:129], v[46:49]
    ds_read_b64_tr_b16 v[138:139], v158 offset:64
    ds_read_b64_tr_b16 v[140:141], v158 offset:2368
    s_add_u32 m0, s56, 94208
    s_nop 0
    buffer_load_dwordx4 v162, s[40:43], s74 offen lds
    s_add_u32 s74, s74, s80
    s_waitcnt lgkmcnt(14)
    v_mfma_f32_16x16x32_bf16 v[50:53], v[142:145], v[114:117], v[50:53]
    v_mfma_f32_16x16x32_bf16 v[54:57], v[142:145], v[118:121], v[54:57]
    v_mfma_f32_16x16x32_bf16 v[58:61], v[142:145], v[122:125], v[58:61]
    v_mfma_f32_16x16x32_bf16 v[62:65], v[142:145], v[126:129], v[62:65]
    ds_read_b64_tr_b16 v[142:143], v158 offset:9216
    ds_read_b64_tr_b16 v[144:145], v158 offset:11520
    s_add_u32 m0, s56, 106496
    s_nop 0
    buffer_load_dwordx4 v163, s[44:47], s75 offen lds
    s_add_u32 s75, s75, s81
    s_waitcnt lgkmcnt(14)
    v_mfma_f32_16x16x32_bf16 v[66:69], v[146:149], v[114:117], v[66:69]
    v_mfma_f32_16x16x32_bf16 v[70:73], v[146:149], v[118:121], v[70:73]
    v_mfma_f32_16x16x32_bf16 v[74:77], v[146:149], v[122:125], v[74:77]
    v_mfma_f32_16x16x32_bf16 v[78:81], v[146:149], v[126:129], v[78:81]
    ds_read_b64_tr_b16 v[146:147], v158 offset:9248
    ds_read_b64_tr_b16 v[148:149], v158 offset:11552
    s_add_u32 m0, s56, 118784
    s_nop 0
    buffer_load_dwordx4 v164, s[48:51], s76 offen lds
    s_add_u32 s76, s76, s82
    s_waitcnt lgkmcnt(14)
    v_mfma_f32_16x16x32_bf16 v[82:85], v[150:153], v[114:117], v[82:85]
    v_mfma_f32_16x16x32_bf16 v[86:89], v[150:153], v[118:121], v[86:89]
    v_mfma_f32_16x16x32_bf16 v[90:93], v[150:153], v[122:125], v[90:93]
    v_mfma_f32_16x16x32_bf16 v[94:97], v[150:153], v[126:129], v[94:97]
    ds_read_b64_tr_b16 v[150:151], v158 offset:9280
    ds_read_b64_tr_b16 v[152:153], v158 offset:11584
    s_cmp_eq_u32 s57, 1
    s_cbranch_scc1 L101_d
    s_add_u32 m0, s56, 131072
    s_nop 0
    buffer_load_dwordx4 v165, s[52:55], s77 offen lds
    s_add_u32 s77, s77, s83
L101_d:
    ds_read_b128 v[114:117], v155 offset:0
    ds_read_b128 v[118:121], v155 offset:2048
    ds_read_b128 v[122:125], v155 offset:4096
    ds_read_b128 v[126:129], v155 offset:6144
    s_waitcnt lgkmcnt(14)
    v_mfma_f32_16x16x32_bf16 v[2:5], v[130:133], v[98:101], v[2:5]
    v_mfma_f32_16x16x32_bf16 v[6:9], v[130:133], v[102:105], v[6:9]
    v_mfma_f32_16x16x32_bf16 v[10:13], v[130:133], v[106:109], v[10:13]
    v_mfma_f32_16x16x32_bf16 v[14:17], v[130:133], v[110:113], v[14:17]
    ds_read_b64_tr_b16 v[130:131], v158 offset:18432
    ds_read_b64_tr_b16 v[132:133], v158 offset:20736
    s_waitcnt lgkmcnt(14)
    v_mfma_f32_16x16x32_bf16 v[18:21], v[134:137], v[98:101], v[18:21]
    v_mfma_f32_16x16x32_bf16 v[22:25], v[134:137], v[102:105], v[22:25]
    v_mfma_f32_16x16x32_bf16 v[26:29], v[134:137], v[106:109], v[26:29]
    v_mfma_f32_16x16x32_bf16 v[30:33], v[134:137], v[110:113], v[30:33]
    ds_read_b64_tr_b16 v[134:135], v158 offset:18464
    ds_read_b64_tr_b16 v[136:137], v158 offset:20768
    s_waitcnt lgkmcnt(14)
    v_mfma_f32_16x16x32_bf16 v[34:37], v[138:141], v[98:101], v[34:37]
    v_mfma_f32_16x16x32_bf16 v[38:41], v[138:141], v[102:105], v[38:41]
    v_mfma_f32_16x16x32_bf16 v[42:45], v[138:141], v[106:109], v[42:45]
    v_mfma_f32_16x16x32_bf16 v[46:49], v[138:141], v[110:113], v[46:49]
    ds_read_b64_tr_b16 v[138:139], v158 offset:18496
    ds_read_b64_tr_b16 v[140:141], v158 offset:20800
    s_waitcnt lgkmcnt(14)
    v_mfma_f32_16x16x32_bf16 v[50:53], v[142:145], v[98:101], v[50:53]
    v_mfma_f32_16x16x32_bf16 v[54:57], v[142:145], v[102:105], v[54:57]
    v_mfma_f32_16x16x32_bf16 v[58:61], v[142:145], v[106:109], v[58:61]
    v_mfma_f32_16x16x32_bf16 v[62:65], v[142:145], v[110:113], v[62:65]
    ds_read_b64_tr_b16 v[142:143], v158 offset:27648
    ds_read_b64_tr_b16 v[144:145], v158 offset:29952
    s_waitcnt lgkmcnt(14)
    v_mfma_f32_16x16x32_bf16 v[66:69], v[146:149], v[98:101], v[66:69]
    v_mfma_f32_16x16x32_bf16 v[70:73], v[146:149], v[102:105], v[70:73]
    v_mfma_f32_16x16x32_bf16 v[74:77], v[146:149], v[106:109], v[74:77]
    v_mfma_f32_16x16x32_bf16 v[78:81], v[146:149], v[110:113], v[78:81]
    ds_read_b64_tr_b16 v[146:147], v158 offset:27680
    ds_read_b64_tr_b16 v[148:149], v158 offset:29984
    s_waitcnt lgkmcnt(14)
    v_mfma_f32_16x16x32_bf16 v[82:85], v[150:153], v[98:101], v[82:85]
    v_mfma_f32_16x16x32_bf16 v[86:89], v[150:153], v[102:105], v[86:89]
    v_mfma_f32_16x16x32_bf16 v[90:93], v[150:153], v[106:109], v[90:93]
    v_mfma_f32_16x16x32_bf16 v[94:97], v[150:153], v[110:113], v[94:97]
    ds_read_b64_tr_b16 v[150:151], v158 offset:27712
    ds_read_b64_tr_b16 v[152:153], v158 offset:30016
    s_waitcnt lgkmcnt(0)
    s_waitcnt vmcnt(0)
    s_barrier
    ds_read_b128 v[98:101], v156 offset:0
    ds_read_b128 v[102:105], v156 offset:2048
    ds_read_b128 v[106:109], v156 offset:4096
    ds_read_b128 v[110:113], v156 offset:6144
    s_waitcnt lgkmcnt(14)
    v_mfma_f32_16x16x32_bf16 v[2:5], v[130:133], v[114:117], v[2:5]
    v_mfma_f32_16x16x32_bf16 v[6:9], v[130:133], v[118:121], v[6:9]
    v_mfma_f32_16x16x32_bf16 v[10:13], v[130:133], v[122:125], v[10:13]
    v_mfma_f32_16x16x32_bf16 v[14:17], v[130:133], v[126:129], v[14:17]
    ds_read_b64_tr_b16 v[130:131], v159 offset:0
    ds_read_b64_tr_b16 v[132:133], v159 offset:2304
    s_add_u32 m0, s56, 0
    s_nop 0
    buffer_load_dwordx4 v160, s[32:35], s72 offen lds
    s_add_u32 s72, s72, s78
    s_waitcnt lgkmcnt(14)
    v_mfma_f32_16x16x32_bf16 v[18:21], v[134:137], v[114:117], v[18:21]
    v_mfma_f32_16x16x32_bf16 v[22:25], v[134:137], v[118:121], v[22:25]
    v_mfma_f32_16x16x32_bf16 v[26:29], v[134:137], v[122:125], v[26:29]
    v_mfma_f32_16x16x32_bf16 v[30:33], v[134:137], v[126:129], v[30:33]
    ds_read_b64_tr_b16 v[134:135], v159 offset:32
    ds_read_b64_tr_b16 v[136:137], v159 offset:2336
    s_add_u32 m0, s56, 12288
    s_nop 0
    buffer_load_dwordx4 v161, s[36:39], s73 offen lds
    s_add_u32 s73, s73, s79
    s_waitcnt lgkmcnt(14)
    v_mfma_f32_16x16x32_bf16 v[34:37], v[138:141], v[114:117], v[34:37]
    v_mfma_f32_16x16x32_bf16 v[38:41], v[138:141], v[118:121], v[38:41]
    v_mfma_f32_16x16x32_bf16 v[42:45], v[138:141], v[122:125], v[42:45]
    v_mfma_f32_16x16x32_bf16 v[46:49], v[138:141], v[126:129], v[46:49]
    ds_read_b64_tr_b16 v[138:139], v159 offset:64
    ds_read_b64_tr_b16 v[140:141], v159 offset:2368
    s_add_u32 m0, s56, 24576
    s_nop 0
    buffer_load_dwordx4 v162, s[40:43], s74 offen lds
    s_add_u32 s74, s74, s80
    s_waitcnt lgkmcnt(14)
    v_mfma_f32_16x16x32_bf16 v[50:53], v[142:145], v[114:117], v[50:53]
    v_mfma_f32_16x16x32_bf16 v[54:57], v[142:145], v[118:121], v[54:57]
    v_mfma_f32_16x16x32_bf16 v[58:61], v[142:145], v[122:125], v[58:61]
    v_mfma_f32_16x16x32_bf16 v[62:65], v[142:145], v[126:129], v[62:65]
    ds_read_b64_tr_b16 v[142:143], v159 offset:9216
    ds_read_b64_tr_b16 v[144:145], v159 offset:11520
    s_add_u32 m0, s56, 36864
    s_nop 0
    buffer_load_dwordx4 v163, s[44:47], s75 offen lds
    s_add_u32 s75, s75, s81
    s_waitcnt lgkmcnt(14)
    v_mfma_f32_16x16x32_bf16 v[66:69], v[146:149], v[114:117], v[66:69]
    v_mfma_f32_16x16x32_bf16 v[70:73], v[146:149], v[118:121], v[70:73]
    v_mfma_f32_16x16x32_bf16 v[74:77], v[146:149], v[122:125], v[74:77]
    v_mfma_f32_16x16x32_bf16 v[78:81], v[146:149], v[126:129], v[78:81]
    ds_read_b64_tr_b16 v[146:147], v159 offset:9248
    ds_read_b64_tr_b16 v[148:149], v159 offset:11552
    s_add_u32 m0, s56, 49152
    s_nop 0
    buffer_load_dwordx4 v164, s[48:51], s76 offen lds
    s_add_u32 s76, s76, s82
    s_waitcnt lgkmcnt(14)
    v_mfma_f32_16x16x32_bf16 v[82:85], v[150:153], v[114:117], v[82:85]
    v_mfma_f32_16x16x32_bf16 v[86:89], v[150:153], v[118:121], v[86:89]
    v_mfma_f32_16x16x32_bf16 v[90:93], v[150:153], v[122:125], v[90:93]
    v_mfma_f32_16x16x32_bf16 v[94:97], v[150:153], v[126:129], v[94:97]
    ds_read_b64_tr_b16 v[150:151], v159 offset:9280
    ds_read_b64_tr_b16 v[152:153], v159 offset:11584
    s_cmp_eq_u32 s57, 1
    s_cbranch_scc1 L102_d
    s_add_u32 m0, s56, 61440
    s_nop 0
    buffer_load_dwordx4 v165, s[52:55], s77 offen lds
    s_add_u32 s77, s77, s83
L102_d:
    ds_read_b128 v[114:117], v157 offset:0
    ds_read_b128 v[118:121], v157 offset:2048
    ds_read_b128 v[122:125], v157 offset:4096
    ds_read_b128 v[126:129], v157 offset:6144
    s_waitcnt lgkmcnt(14)
    v_mfma_f32_16x16x32_bf16 v[2:5], v[130:133], v[98:101], v[2:5]
    v_mfma_f32_16x16x32_bf16 v[6:9], v[130:133], v[102:105], v[6:9]
    v_mfma_f32_16x16x32_bf16 v[10:13], v[130:133], v[106:109], v[10:13]
    v_mfma_f32_16x16x32_bf16 v[14:17], v[130:133], v[110:113], v[14:17]
    ds_read_b64_tr_b16 v[130:131], v159 offset:18432
    ds_read_b64_tr_b16 v[132:133], v159 offset:20736
    s_waitcnt lgkmcnt(14)
    v_mfma_f32_16x16x32_bf16 v[18:21], v[134:137], v[98:101], v[18:21]
    v_mfma_f32_16x16x32_bf16 v[22:25], v[134:137], v[102:105], v[22:25]
    v_mfma_f32_16x16x32_bf16 v[26:29], v[134:137], v[106:109], v[26:29]
    v_mfma_f32_16x16x32_bf16 v[30:33], v[134:137], v[110:113], v[30:33]
    ds_read_b64_tr_b16 v[134:135], v159 offset:18464
    ds_read_b64_tr_b16 v[136:137], v159 offset:20768
    s_waitcnt lgkmcnt(14)
    v_mfma_f32_16x16x32_bf16 v[34:37], v[138:141], v[98:101], v[34:37]
    v_mfma_f32_16x16x32_bf16 v[38:41], v[138:141], v[102:105], v[38:41]
    v_mfma_f32_16x16x32_bf16 v[42:45], v[138:141], v[106:109], v[42:45]
    v_mfma_f32_16x16x32_bf16 v[46:49], v[138:141], v[110:113], v[46:49]
    ds_read_b64_tr_b16 v[138:139], v159 offset:18496
    ds_read_b64_tr_b16 v[140:141], v159 offset:20800
    s_waitcnt lgkmcnt(14)
    v_mfma_f32_16x16x32_bf16 v[50:53], v[142:145], v[98:101], v[50:53]
    v_mfma_f32_16x16x32_bf16 v[54:57], v[142:145], v[102:105], v[54:57]
    v_mfma_f32_16x16x32_bf16 v[58:61], v[142:145], v[106:109], v[58:61]
    v_mfma_f32_16x16x32_bf16 v[62:65], v[142:145], v[110:113], v[62:65]
    ds_read_b64_tr_b16 v[142:143], v159 offset:27648
    ds_read_b64_tr_b16 v[144:145], v159 offset:29952
    s_waitcnt lgkmcnt(14)
    v_mfma_f32_16x16x32_bf16 v[66:69], v[146:149], v[98:101], v[66:69]
    v_mfma_f32_16x16x32_bf16 v[70:73], v[146:149], v[102:105], v[70:73]
    v_mfma_f32_16x16x32_bf16 v[74:77], v[146:149], v[106:109], v[74:77]
    v_mfma_f32_16x16x32_bf16 v[78:81], v[146:149], v[110:113], v[78:81]
    ds_read_b64_tr_b16 v[146:147], v159 offset:27680
    ds_read_b64_tr_b16 v[148:149], v159 offset:29984
    s_waitcnt lgkmcnt(14)
    v_mfma_f32_16x16x32_bf16 v[82:85], v[150:153], v[98:101], v[82:85]
    v_mfma_f32_16x16x32_bf16 v[86:89], v[150:153], v[102:105], v[86:89]
    v_mfma_f32_16x16x32_bf16 v[90:93], v[150:153], v[106:109], v[90:93]
    v_mfma_f32_16x16x32_bf16 v[94:97], v[150:153], v[110:113], v[94:97]
    ds_read_b64_tr_b16 v[150:151], v159 offset:27712
    ds_read_b64_tr_b16 v[152:153], v159 offset:30016
    s_waitcnt lgkmcnt(0)
    s_waitcnt vmcnt(0)
    s_barrier
    ds_read_b128 v[98:101], v154 offset:0
    ds_read_b128 v[102:105], v154 offset:2048
    ds_read_b128 v[106:109], v154 offset:4096
    ds_read_b128 v[110:113], v154 offset:6144
    s_waitcnt lgkmcnt(14)
    v_mfma_f32_16x16x32_bf16 v[2:5], v[130:133], v[114:117], v[2:5]
    v_mfma_f32_16x16x32_bf16 v[6:9], v[130:133], v[118:121], v[6:9]
    v_mfma_f32_16x16x32_bf16 v[10:13], v[130:133], v[122:125], v[10:13]
    v_mfma_f32_16x16x32_bf16 v[14:17], v[130:133], v[126:129], v[14:17]
    ds_read_b64_tr_b16 v[130:131], v158 offset:0
    ds_read_b64_tr_b16 v[132:133], v158 offset:2304
    s_waitcnt lgkmcnt(14)
    v_mfma_f32_16x16x32_bf16 v[18:21], v[134:137], v[114:117], v[18:21]
    v_mfma_f32_16x16x32_bf16 v[22:25], v[134:137], v[118:121], v[22:25]
    v_mfma_f32_16x16x32_bf16 v[26:29], v[134:137], v[122:125], v[26:29]
    v_mfma_f32_16x16x32_bf16 v[30:33], v[134:137], v[126:129], v[30:33]
    ds_read_b64_tr_b16 v[134:135], v158 offset:32
    ds_read_b64_tr_b16 v[136:137], v158 offset:2336
    s_waitcnt lgkmcnt(14)
    v_mfma_f32_16x16x32_bf16 v[34:37], v[138:141], v[114:117], v[34:37]
    v_mfma_f32_16x16x32_bf16 v[38:41], v[138:141], v[118:121], v[38:41]
    v_mfma_f32_16x16x32_bf16 v[42:45], v[138:141], v[122:125], v[42:45]
    v_mfma_f32_16x16x32_bf16 v[46:49], v[138:141], v[126:129], v[46:49]
    ds_read_b64_tr_b16 v[138:139], v158 offset:64
    ds_read_b64_tr_b16 v[140:141], v158 offset:2368
    s_waitcnt lgkmcnt(14)
    v_mfma_f32_16x16x32_bf16 v[50:53], v[142:145], v[114:117], v[50:53]
    v_mfma_f32_16x16x32_bf16 v[54:57], v[142:145], v[118:121], v[54:57]
    v_mfma_f32_16x16x32_bf16 v[58:61], v[142:145], v[122:125], v[58:61]
    v_mfma_f32_16x16x32_bf16 v[62:65], v[142:145], v[126:129], v[62:65]
    ds_read_b64_tr_b16 v[142:143], v158 offset:9216
    ds_read_b64_tr_b16 v[144:145], v158 offset:11520
    s_waitcnt lgkmcnt(14)
    v_mfma_f32_16x16x32_bf16 v[66:69], v[146:149], v[114:117], v[66:69]
    v_mfma_f32_16x16x32_bf16 v[70:73], v[146:149], v[118:121], v[70:73]
    v_mfma_f32_16x16x32_bf16 v[74:77], v[146:149], v[122:125], v[74:77]
    v_mfma_f32_16x16x32_bf16 v[78:81], v[146:149], v[126:129], v[78:81]
    ds_read_b64_tr_b16 v[146:147], v158 offset:9248
    ds_read_b64_tr_b16 v[148:149], v158 offset:11552
    s_waitcnt lgkmcnt(14)
    v_mfma_f32_16x16x32_bf16 v[82:85], v[150:153], v[114:117], v[82:85]
    v_mfma_f32_16x16x32_bf16 v[86:89], v[150:153], v[118:121], v[86:89]
    v_mfma_f32_16x16x32_bf16 v[90:93], v[150:153], v[122:125], v[90:93]
    v_mfma_f32_16x16x32_bf16 v[94:97], v[150:153], v[126:129], v[94:97]
    ds_read_b64_tr_b16 v[150:151], v158 offset:9280
    ds_read_b64_tr_b16 v[152:153], v158 offset:11584
    ds_read_b128 v[114:117], v155 offset:0
    ds_read_b128 v[118:121], v155 offset:2048
    ds_read_b128 v[122:125], v155 offset:4096
    ds_read_b128 v[126:129], v155 offset:6144
    s_waitcnt lgkmcnt(14)
    v_mfma_f32_16x16x32_bf16 v[2:5], v[130:133], v[98:101], v[2:5]
    v_mfma_f32_16x16x32_bf16 v[6:9], v[130:133], v[102:105], v[6:9]
    v_mfma_f32_16x16x32_bf16 v[10:13], v[130:133], v[106:109], v[10:13]
    v_mfma_f32_16x16x32_bf16 v[14:17], v[130:133], v[110:113], v[14:17]
    ds_read_b64_tr_b16 v[130:131], v158 offset:18432
    ds_read_b64_tr_b16 v[132:133], v158 offset:20736
    s_waitcnt lgkmcnt(14)
    v_mfma_f32_16x16x32_bf16 v[18:21], v[134:137], v[98:101], v[18:21]
    v_mfma_f32_16x16x32_bf16 v[22:25], v[134:137], v[102:105], v[22:25]
    v_mfma_f32_16x16x32_bf16 v[26:29], v[134:137], v[106:109], v[26:29]
    v_mfma_f32_16x16x32_bf16 v[30:33], v[134:137], v[110:113], v[30:33]
    ds_read_b64_tr_b16 v[134:135], v158 offset:18464
    ds_read_b64_tr_b16 v[136:137], v158 offset:20768
    s_waitcnt lgkmcnt(14)
    v_mfma_f32_16x16x32_bf16 v[34:37], v[138:141], v[98:101], v[34:37]
    v_mfma_f32_16x16x32_bf16 v[38:41], v[138:141], v[102:105], v[38:41]
    v_mfma_f32_16x16x32_bf16 v[42:45], v[138:141], v[106:109], v[42:45]
    v_mfma_f32_16x16x32_bf16 v[46:49], v[138:141], v[110:113], v[46:49]
    ds_read_b64_tr_b16 v[138:139], v158 offset:18496
    ds_read_b64_tr_b16 v[140:141], v158 offset:20800
    s_waitcnt lgkmcnt(14)
    v_mfma_f32_16x16x32_bf16 v[50:53], v[142:145], v[98:101], v[50:53]
    v_mfma_f32_16x16x32_bf16 v[54:57], v[142:145], v[102:105], v[54:57]
    v_mfma_f32_16x16x32_bf16 v[58:61], v[142:145], v[106:109], v[58:61]
    v_mfma_f32_16x16x32_bf16 v[62:65], v[142:145], v[110:113], v[62:65]
    ds_read_b64_tr_b16 v[142:143], v158 offset:27648
    ds_read_b64_tr_b16 v[144:145], v158 offset:29952
    s_waitcnt lgkmcnt(14)
    v_mfma_f32_16x16x32_bf16 v[66:69], v[146:149], v[98:101], v[66:69]
    v_mfma_f32_16x16x32_bf16 v[70:73], v[146:149], v[102:105], v[70:73]
    v_mfma_f32_16x16x32_bf16 v[74:77], v[146:149], v[106:109], v[74:77]
    v_mfma_f32_16x16x32_bf16 v[78:81], v[146:149], v[110:113], v[78:81]
    ds_read_b64_tr_b16 v[146:147], v158 offset:27680
    ds_read_b64_tr_b16 v[148:149], v158 offset:29984
    s_waitcnt lgkmcnt(14)
    v_mfma_f32_16x16x32_bf16 v[82:85], v[150:153], v[98:101], v[82:85]
    v_mfma_f32_16x16x32_bf16 v[86:89], v[150:153], v[102:105], v[86:89]
    v_mfma_f32_16x16x32_bf16 v[90:93], v[150:153], v[106:109], v[90:93]
    v_mfma_f32_16x16x32_bf16 v[94:97], v[150:153], v[110:113], v[94:97]
    ds_read_b64_tr_b16 v[150:151], v158 offset:27712
    ds_read_b64_tr_b16 v[152:153], v158 offset:30016
    s_waitcnt lgkmcnt(10)
    v_mfma_f32_16x16x32_bf16 v[2:5], v[130:133], v[114:117], v[2:5]
    v_mfma_f32_16x16x32_bf16 v[6:9], v[130:133], v[118:121], v[6:9]
    v_mfma_f32_16x16x32_bf16 v[10:13], v[130:133], v[122:125], v[10:13]
    v_mfma_f32_16x16x32_bf16 v[14:17], v[130:133], v[126:129], v[14:17]
    s_waitcnt lgkmcnt(8)
    v_mfma_f32_16x16x32_bf16 v[18:21], v[134:137], v[114:117], v[18:21]
    v_mfma_f32_16x16x32_bf16 v[22:25], v[134:137], v[118:121], v[22:25]
    v_mfma_f32_16x16x32_bf16 v[26:29], v[134:137], v[122:125], v[26:29]
    v_mfma_f32_16x16x32_bf16 v[30:33], v[134:137], v[126:129], v[30:33]
    s_waitcnt lgkmcnt(6)
    v_mfma_f32_16x16x32_bf16 v[34:37], v[138:141], v[114:117], v[34:37]
    v_mfma_f32_16x16x32_bf16 v[38:41], v[138:141], v[118:121], v[38:41]
    v_mfma_f32_16x16x32_bf16 v[42:45], v[138:141], v[122:125], v[42:45]
    v_mfma_f32_16x16x32_bf16 v[46:49], v[138:141], v[126:129], v[46:49]
    s_waitcnt lgkmcnt(4)
    v_mfma_f32_16x16x32_bf16 v[50:53], v[142:145], v[114:117], v[50:53]
    v_mfma_f32_16x16x32_bf16 v[54:57], v[142:145], v[118:121], v[54:57]
    v_mfma_f32_16x16x32_bf16 v[58:61], v[142:145], v[122:125], v[58:61]
    v_mfma_f32_16x16x32_bf16 v[62:65], v[142:145], v[126:129], v[62:65]
    s_waitcnt lgkmcnt(2)
    v_mfma_f32_16x16x32_bf16 v[66:69], v[146:149], v[114:117], v[66:69]
    v_mfma_f32_16x16x32_bf16 v[70:73], v[146:149], v[118:121], v[70:73]
    v_mfma_f32_16x16x32_bf16 v[74:77], v[146:149], v[122:125], v[74:77]
    v_mfma_f32_16x16x32_bf16 v[78:81], v[146:149], v[126:129], v[78:81]
    s_waitcnt lgkmcnt(0)
    v_mfma_f32_16x16x32_bf16 v[82:85], v[150:153], v[114:117], v[82:85]
    v_mfma_f32_16x16x32_bf16 v[86:89], v[150:153], v[118:121], v[86:89]
    v_mfma_f32_16x16x32_bf16 v[90:93], v[150:153], v[122:125], v[90:93]
    v_mfma_f32_16x16x32_bf16 v[94:97], v[150:153], v[126:129], v[94:97]
    s_lshl_b32 s4, s69, 8
    s_mul_i32 s5, s62, 64
    s_add_u32 s4, s4, s5
    v_and_b32 v1, 15, v0
    v_add_u32 v1, s4, v1
    s_mov_b32 s4, 9216
    v_mul_lo_u32 v1, v1, s4
    s_mul_i32 s4, s68, 288
    s_mul_i32 s5, s63, 96
    s_add_u32 s4, s4, s5
    v_add_u32 v1, s4, v1
    s_mov_b32 s6, 0xbfb8aa3b
    s_mov_b32 s7, 0xbfb8aa3b
    s_mov_b32 s4, 1.0
    s_mov_b32 s5, 1.0
    v_lshrrev_b32 v131, 5, v0
    v_lshl_add_u32 v1, v131, 4, v1
    v_bfe_u32 v130, v0, 4, 1
    v_lshl_add_u32 v132, v130, 5, v1
    s_mov_b32 s8, 147456
    v_mul_lo_u32 v130, v130, s8
    v_add_u32 v133, v130, v1
    v_cvt_pk_bf16_f32 v98, v2, v3
    v_cvt_pk_bf16_f32 v99, v4, v5
    v_cvt_pk_bf16_f32 v100, v50, v51
    v_cvt_pk_bf16_f32 v101, v52, v53
    v_lshlrev_b32 v2, 16, v98
    v_and_b32 v3, 0xffff0000, v98
    v_lshlrev_b32 v4, 16, v99
    v_and_b32 v5, 0xffff0000, v99
    v_lshlrev_b32 v50, 16, v100
    v_and_b32 v51, 0xffff0000, v100
    v_lshlrev_b32 v52, 16, v101
    v_and_b32 v53, 0xffff0000, v101
    v_pk_mul_f32 v[102:103], v[2:3], s[6:7]
    v_pk_mul_f32 v[104:105], v[4:5], s[6:7]
    v_exp_f32 v102, v102
    v_exp_f32 v103, v103
    v_exp_f32 v104, v104
    v_exp_f32 v105, v105
    v_pk_add_f32 v[102:103], v[102:103], s[4:5]
    v_pk_add_f32 v[104:105], v[104:105], s[4:5]
    v_rcp_f32 v102, v102
    v_rcp_f32 v103, v103
    v_rcp_f32 v104, v104
    v_rcp_f32 v105, v105
    v_pk_mul_f32 v[2:3], v[2:3], v[102:103]
    v_pk_mul_f32 v[4:5], v[4:5], v[104:105]
    v_cvt_pk_bf16_f32 v98, v2, v3
    v_cvt_pk_bf16_f32 v99, v4, v5
    v_lshlrev_b32 v2, 16, v98
    v_and_b32 v3, 0xffff0000, v98
    v_lshlrev_b32 v4, 16, v99
    v_and_b32 v5, 0xffff0000, v99
    v_pk_mul_f32 v[2:3], v[2:3], v[50:51]
    v_pk_mul_f32 v[4:5], v[4:5], v[52:53]
    v_cvt_pk_bf16_f32 v134, v2, v3
    v_cvt_pk_bf16_f32 v135, v4, v5
    v_cvt_pk_bf16_f32 v106, v18, v19
    v_cvt_pk_bf16_f32 v107, v20, v21
    v_cvt_pk_bf16_f32 v108, v66, v67
    v_cvt_pk_bf16_f32 v109, v68, v69
    v_lshlrev_b32 v18, 16, v106
    v_and_b32 v19, 0xffff0000, v106
    v_lshlrev_b32 v20, 16, v107
    v_and_b32 v21, 0xffff0000, v107
    v_lshlrev_b32 v66, 16, v108
    v_and_b32 v67, 0xffff0000, v108
    v_lshlrev_b32 v68, 16, v109
    v_and_b32 v69, 0xffff0000, v109
    v_pk_mul_f32 v[110:111], v[18:19], s[6:7]
    v_pk_mul_f32 v[112:113], v[20:21], s[6:7]
    v_exp_f32 v110, v110
    v_exp_f32 v111, v111
    v_exp_f32 v112, v112
    v_exp_f32 v113, v113
    v_pk_add_f32 v[110:111], v[110:111], s[4:5]
    v_pk_add_f32 v[112:113], v[112:113], s[4:5]
    v_rcp_f32 v110, v110
    v_rcp_f32 v111, v111
    v_rcp_f32 v112, v112
    v_rcp_f32 v113, v113
    v_pk_mul_f32 v[18:19], v[18:19], v[110:111]
    v_pk_mul_f32 v[20:21], v[20:21], v[112:113]
    v_cvt_pk_bf16_f32 v106, v18, v19
    v_cvt_pk_bf16_f32 v107, v20, v21
    v_lshlrev_b32 v18, 16, v106
    v_and_b32 v19, 0xffff0000, v106
    v_lshlrev_b32 v20, 16, v107
    v_and_b32 v21, 0xffff0000, v107
    v_pk_mul_f32 v[18:19], v[18:19], v[66:67]
    v_pk_mul_f32 v[20:21], v[20:21], v[68:69]
    v_cvt_pk_bf16_f32 v136, v18, v19
    v_cvt_pk_bf16_f32 v137, v20, v21
    s_nop 0
    v_permlane16_swap_b32 v134, v136
    v_permlane16_swap_b32 v135, v137
    s_mov_b32 s8, 0
    buffer_store_dwordx4 v[134:137], v132, s[20:23], s8 offen sc1
    v_cvt_pk_bf16_f32 v114, v6, v7
    v_cvt_pk_bf16_f32 v115, v8, v9
    v_cvt_pk_bf16_f32 v116, v54, v55
    v_cvt_pk_bf16_f32 v117, v56, v57
    v_lshlrev_b32 v6, 16, v114
    v_and_b32 v7, 0xffff0000, v114
    v_lshlrev_b32 v8, 16, v115
    v_and_b32 v9, 0xffff0000, v115
    v_lshlrev_b32 v54, 16, v116
    v_and_b32 v55, 0xffff0000, v116
    v_lshlrev_b32 v56, 16, v117
    v_and_b32 v57, 0xffff0000, v117
    v_pk_mul_f32 v[118:119], v[6:7], s[6:7]
    v_pk_mul_f32 v[120:121], v[8:9], s[6:7]
    v_exp_f32 v118, v118
    v_exp_f32 v119, v119
    v_exp_f32 v120, v120
    v_exp_f32 v121, v121
    v_pk_add_f32 v[118:119], v[118:119], s[4:5]
    v_pk_add_f32 v[120:121], v[120:121], s[4:5]
    v_rcp_f32 v118, v118
    v_rcp_f32 v119, v119
    v_rcp_f32 v120, v120
    v_rcp_f32 v121, v121
    v_pk_mul_f32 v[6:7], v[6:7], v[118:119]
    v_pk_mul_f32 v[8:9], v[8:9], v[120:121]
    v_cvt_pk_bf16_f32 v114, v6, v7
    v_cvt_pk_bf16_f32 v115, v8, v9
    v_lshlrev_b32 v6, 16, v114
    v_and_b32 v7, 0xffff0000, v114
    v_lshlrev_b32 v8, 16, v115
    v_and_b32 v9, 0xffff0000, v115
    v_pk_mul_f32 v[6:7], v[6:7], v[54:55]
    v_pk_mul_f32 v[8:9], v[8:9], v[56:57]
    v_cvt_pk_bf16_f32 v138, v6, v7
    v_cvt_pk_bf16_f32 v139, v8, v9
    v_cvt_pk_bf16_f32 v122, v22, v23
    v_cvt_pk_bf16_f32 v123, v24, v25
    v_cvt_pk_bf16_f32 v124, v70, v71
    v_cvt_pk_bf16_f32 v125, v72, v73
    v_lshlrev_b32 v22, 16, v122
    v_and_b32 v23, 0xffff0000, v122
    v_lshlrev_b32 v24, 16, v123
    v_and_b32 v25, 0xffff0000, v123
    v_lshlrev_b32 v70, 16, v124
    v_and_b32 v71, 0xffff0000, v124
    v_lshlrev_b32 v72, 16, v125
    v_and_b32 v73, 0xffff0000, v125
    v_pk_mul_f32 v[126:127], v[22:23], s[6:7]
    v_pk_mul_f32 v[128:129], v[24:25], s[6:7]
    v_exp_f32 v126, v126
    v_exp_f32 v127, v127
    v_exp_f32 v128, v128
    v_exp_f32 v129, v129
    v_pk_add_f32 v[126:127], v[126:127], s[4:5]
    v_pk_add_f32 v[128:129], v[128:129], s[4:5]
    v_rcp_f32 v126, v126
    v_rcp_f32 v127, v127
    v_rcp_f32 v128, v128
    v_rcp_f32 v129, v129
    v_pk_mul_f32 v[22:23], v[22:23], v[126:127]
    v_pk_mul_f32 v[24:25], v[24:25], v[128:129]
    v_cvt_pk_bf16_f32 v122, v22, v23
    v_cvt_pk_bf16_f32 v123, v24, v25
    v_lshlrev_b32 v22, 16, v122
    v_and_b32 v23, 0xffff0000, v122
    v_lshlrev_b32 v24, 16, v123
    v_and_b32 v25, 0xffff0000, v123
    v_pk_mul_f32 v[22:23], v[22:23], v[70:71]
    v_pk_mul_f32 v[24:25], v[24:25], v[72:73]
    v_cvt_pk_bf16_f32 v140, v22, v23
    v_cvt_pk_bf16_f32 v141, v24, v25
    s_nop 0
    v_permlane16_swap_b32 v138, v140
    v_permlane16_swap_b32 v139, v141
    s_mov_b32 s8, 147456
    buffer_store_dwordx4 v[138:141], v132, s[20:23], s8 offen sc1
    v_cvt_pk_bf16_f32 v98, v34, v35
    v_cvt_pk_bf16_f32 v99, v36, v37
    v_cvt_pk_bf16_f32 v100, v82, v83
    v_cvt_pk_bf16_f32 v101, v84, v85
    v_lshlrev_b32 v34, 16, v98
    v_and_b32 v35, 0xffff0000, v98
    v_lshlrev_b32 v36, 16, v99
    v_and_b32 v37, 0xffff0000, v99
    v_lshlrev_b32 v82, 16, v100
    v_and_b32 v83, 0xffff0000, v100
    v_lshlrev_b32 v84, 16, v101
    v_and_b32 v85, 0xffff0000, v101
    v_pk_mul_f32 v[102:103], v[34:35], s[6:7]
    v_pk_mul_f32 v[104:105], v[36:37], s[6:7]
    v_exp_f32 v102, v102
    v_exp_f32 v103, v103
    v_exp_f32 v104, v104
    v_exp_f32 v105, v105
    v_pk_add_f32 v[102:103], v[102:103], s[4:5]
    v_pk_add_f32 v[104:105], v[104:105], s[4:5]
    v_rcp_f32 v102, v102
    v_rcp_f32 v103, v103
    v_rcp_f32 v104, v104
    v_rcp_f32 v105, v105
    v_pk_mul_f32 v[34:35], v[34:35], v[102:103]
    v_pk_mul_f32 v[36:37], v[36:37], v[104:105]
    v_cvt_pk_bf16_f32 v98, v34, v35
    v_cvt_pk_bf16_f32 v99, v36, v37
    v_lshlrev_b32 v34, 16, v98
    v_and_b32 v35, 0xffff0000, v98
    v_lshlrev_b32 v36, 16, v99
    v_and_b32 v37, 0xffff0000, v99
    v_pk_mul_f32 v[34:35], v[34:35], v[82:83]
    v_pk_mul_f32 v[36:37], v[36:37], v[84:85]
    v_cvt_pk_bf16_f32 v142, v34, v35
    v_cvt_pk_bf16_f32 v143, v36, v37
    v_cvt_pk_bf16_f32 v106, v38, v39
    v_cvt_pk_bf16_f32 v107, v40, v41
    v_cvt_pk_bf16_f32 v108, v86, v87
    v_cvt_pk_bf16_f32 v109, v88, v89
    v_lshlrev_b32 v38, 16, v106
    v_and_b32 v39, 0xffff0000, v106
    v_lshlrev_b32 v40, 16, v107
    v_and_b32 v41, 0xffff0000, v107
    v_lshlrev_b32 v86, 16, v108
    v_and_b32 v87, 0xffff0000, v108
    v_lshlrev_b32 v88, 16, v109
    v_and_b32 v89, 0xffff0000, v109
    v_pk_mul_f32 v[110:111], v[38:39], s[6:7]
    v_pk_mul_f32 v[112:113], v[40:41], s[6:7]
    v_exp_f32 v110, v110
    v_exp_f32 v111, v111
    v_exp_f32 v112, v112
    v_exp_f32 v113, v113
    v_pk_add_f32 v[110:111], v[110:111], s[4:5]
    v_pk_add_f32 v[112:113], v[112:113], s[4:5]
    v_rcp_f32 v110, v110
    v_rcp_f32 v111, v111
    v_rcp_f32 v112, v112
    v_rcp_f32 v113, v113
    v_pk_mul_f32 v[38:39], v[38:39], v[110:111]
    v_pk_mul_f32 v[40:41], v[40:41], v[112:113]
    v_cvt_pk_bf16_f32 v106, v38, v39
    v_cvt_pk_bf16_f32 v107, v40, v41
    v_lshlrev_b32 v38, 16, v106
    v_and_b32 v39, 0xffff0000, v106
    v_lshlrev_b32 v40, 16, v107
    v_and_b32 v41, 0xffff0000, v107
    v_pk_mul_f32 v[38:39], v[38:39], v[86:87]
    v_pk_mul_f32 v[40:41], v[40:41], v[88:89]
    v_cvt_pk_bf16_f32 v144, v38, v39
    v_cvt_pk_bf16_f32 v145, v40, v41
    s_nop 0
    v_permlane16_swap_b32 v142, v144
    v_permlane16_swap_b32 v143, v145
    s_mov_b32 s8, 0
    buffer_store_dwordx4 v[142:145], v133, s[20:23], s8 offen offset:64 sc1
    v_cvt_pk_bf16_f32 v114, v10, v11
    v_cvt_pk_bf16_f32 v115, v12, v13
    v_cvt_pk_bf16_f32 v116, v58, v59
    v_cvt_pk_bf16_f32 v117, v60, v61
    v_lshlrev_b32 v10, 16, v114
    v_and_b32 v11, 0xffff0000, v114
    v_lshlrev_b32 v12, 16, v115
    v_and_b32 v13, 0xffff0000, v115
    v_lshlrev_b32 v58, 16, v116
    v_and_b32 v59, 0xffff0000, v116
    v_lshlrev_b32 v60, 16, v117
    v_and_b32 v61, 0xffff0000, v117
    v_pk_mul_f32 v[118:119], v[10:11], s[6:7]
    v_pk_mul_f32 v[120:121], v[12:13], s[6:7]
    v_exp_f32 v118, v118
    v_exp_f32 v119, v119
    v_exp_f32 v120, v120
    v_exp_f32 v121, v121
    v_pk_add_f32 v[118:119], v[118:119], s[4:5]
    v_pk_add_f32 v[120:121], v[120:121], s[4:5]
    v_rcp_f32 v118, v118
    v_rcp_f32 v119, v119
    v_rcp_f32 v120, v120
    v_rcp_f32 v121, v121
    v_pk_mul_f32 v[10:11], v[10:11], v[118:119]
    v_pk_mul_f32 v[12:13], v[12:13], v[120:121]
    v_cvt_pk_bf16_f32 v114, v10, v11
    v_cvt_pk_bf16_f32 v115, v12, v13
    v_lshlrev_b32 v10, 16, v114
    v_and_b32 v11, 0xffff0000, v114
    v_lshlrev_b32 v12, 16, v115
    v_and_b32 v13, 0xffff0000, v115
    v_pk_mul_f32 v[10:11], v[10:11], v[58:59]
    v_pk_mul_f32 v[12:13], v[12:13], v[60:61]
    v_cvt_pk_bf16_f32 v146, v10, v11
    v_cvt_pk_bf16_f32 v147, v12, v13
    v_cvt_pk_bf16_f32 v122, v26, v27
    v_cvt_pk_bf16_f32 v123, v28, v29
    v_cvt_pk_bf16_f32 v124, v74, v75
    v_cvt_pk_bf16_f32 v125, v76, v77
    v_lshlrev_b32 v26, 16, v122
    v_and_b32 v27, 0xffff0000, v122
    v_lshlrev_b32 v28, 16, v123
    v_and_b32 v29, 0xffff0000, v123
    v_lshlrev_b32 v74, 16, v124
    v_and_b32 v75, 0xffff0000, v124
    v_lshlrev_b32 v76, 16, v125
    v_and_b32 v77, 0xffff0000, v125
    v_pk_mul_f32 v[126:127], v[26:27], s[6:7]
    v_pk_mul_f32 v[128:129], v[28:29], s[6:7]
    v_exp_f32 v126, v126
    v_exp_f32 v127, v127
    v_exp_f32 v128, v128
    v_exp_f32 v129, v129
    v_pk_add_f32 v[126:127], v[126:127], s[4:5]
    v_pk_add_f32 v[128:129], v[128:129], s[4:5]
    v_rcp_f32 v126, v126
    v_rcp_f32 v127, v127
    v_rcp_f32 v128, v128
    v_rcp_f32 v129, v129
    v_pk_mul_f32 v[26:27], v[26:27], v[126:127]
    v_pk_mul_f32 v[28:29], v[28:29], v[128:129]
    v_cvt_pk_bf16_f32 v122, v26, v27
    v_cvt_pk_bf16_f32 v123, v28, v29
    v_lshlrev_b32 v26, 16, v122
    v_and_b32 v27, 0xffff0000, v122
    v_lshlrev_b32 v28, 16, v123
    v_and_b32 v29, 0xffff0000, v123
    v_pk_mul_f32 v[26:27], v[26:27], v[74:75]
    v_pk_mul_f32 v[28:29], v[28:29], v[76:77]
    v_cvt_pk_bf16_f32 v148, v26, v27
    v_cvt_pk_bf16_f32 v149, v28, v29
    s_nop 0
    v_permlane16_swap_b32 v146, v148
    v_permlane16_swap_b32 v147, v149
    s_mov_b32 s8, 294912
    buffer_store_dwordx4 v[146:149], v132, s[20:23], s8 offen sc1
    v_cvt_pk_bf16_f32 v98, v14, v15
    v_cvt_pk_bf16_f32 v99, v16, v17
    v_cvt_pk_bf16_f32 v100, v62, v63
    v_cvt_pk_bf16_f32 v101, v64, v65
    v_lshlrev_b32 v14, 16, v98
    v_and_b32 v15, 0xffff0000, v98
    v_lshlrev_b32 v16, 16, v99
    v_and_b32 v17, 0xffff0000, v99
    v_lshlrev_b32 v62, 16, v100
    v_and_b32 v63, 0xffff0000, v100
    v_lshlrev_b32 v64, 16, v101
    v_and_b32 v65, 0xffff0000, v101
    v_pk_mul_f32 v[102:103], v[14:15], s[6:7]
    v_pk_mul_f32 v[104:105], v[16:17], s[6:7]
    v_exp_f32 v102, v102
    v_exp_f32 v103, v103
    v_exp_f32 v104, v104
    v_exp_f32 v105, v105
    v_pk_add_f32 v[102:103], v[102:103], s[4:5]
    v_pk_add_f32 v[104:105], v[104:105], s[4:5]
    v_rcp_f32 v102, v102
    v_rcp_f32 v103, v103
    v_rcp_f32 v104, v104
    v_rcp_f32 v105, v105
    v_pk_mul_f32 v[14:15], v[14:15], v[102:103]
    v_pk_mul_f32 v[16:17], v[16:17], v[104:105]
    v_cvt_pk_bf16_f32 v98, v14, v15
    v_cvt_pk_bf16_f32 v99, v16, v17
    v_lshlrev_b32 v14, 16, v98
    v_and_b32 v15, 0xffff0000, v98
    v_lshlrev_b32 v16, 16, v99
    v_and_b32 v17, 0xffff0000, v99
    v_pk_mul_f32 v[14:15], v[14:15], v[62:63]
    v_pk_mul_f32 v[16:17], v[16:17], v[64:65]
    v_cvt_pk_bf16_f32 v134, v14, v15
    v_cvt_pk_bf16_f32 v135, v16, v17
    v_cvt_pk_bf16_f32 v106, v30, v31
    v_cvt_pk_bf16_f32 v107, v32, v33
    v_cvt_pk_bf16_f32 v108, v78, v79
    v_cvt_pk_bf16_f32 v109, v80, v81
    v_lshlrev_b32 v30, 16, v106
    v_and_b32 v31, 0xffff0000, v106
    v_lshlrev_b32 v32, 16, v107
    v_and_b32 v33, 0xffff0000, v107
    v_lshlrev_b32 v78, 16, v108
    v_and_b32 v79, 0xffff0000, v108
    v_lshlrev_b32 v80, 16, v109
    v_and_b32 v81, 0xffff0000, v109
    v_pk_mul_f32 v[110:111], v[30:31], s[6:7]
    v_pk_mul_f32 v[112:113], v[32:33], s[6:7]
    v_exp_f32 v110, v110
    v_exp_f32 v111, v111
    v_exp_f32 v112, v112
    v_exp_f32 v113, v113
    v_pk_add_f32 v[110:111], v[110:111], s[4:5]
    v_pk_add_f32 v[112:113], v[112:113], s[4:5]
    v_rcp_f32 v110, v110
    v_rcp_f32 v111, v111
    v_rcp_f32 v112, v112
    v_rcp_f32 v113, v113
    v_pk_mul_f32 v[30:31], v[30:31], v[110:111]
    v_pk_mul_f32 v[32:33], v[32:33], v[112:113]
    v_cvt_pk_bf16_f32 v106, v30, v31
    v_cvt_pk_bf16_f32 v107, v32, v33
    v_lshlrev_b32 v30, 16, v106
    v_and_b32 v31, 0xffff0000, v106
    v_lshlrev_b32 v32, 16, v107
    v_and_b32 v33, 0xffff0000, v107
    v_pk_mul_f32 v[30:31], v[30:31], v[78:79]
    v_pk_mul_f32 v[32:33], v[32:33], v[80:81]
    v_cvt_pk_bf16_f32 v136, v30, v31
    v_cvt_pk_bf16_f32 v137, v32, v33
    s_nop 0
    v_permlane16_swap_b32 v134, v136
    v_permlane16_swap_b32 v135, v137
    s_mov_b32 s8, 442368
    buffer_store_dwordx4 v[134:137], v132, s[20:23], s8 offen sc1
    v_cvt_pk_bf16_f32 v114, v42, v43
    v_cvt_pk_bf16_f32 v115, v44, v45
    v_cvt_pk_bf16_f32 v116, v90, v91
    v_cvt_pk_bf16_f32 v117, v92, v93
    v_lshlrev_b32 v42, 16, v114
    v_and_b32 v43, 0xffff0000, v114
    v_lshlrev_b32 v44, 16, v115
    v_and_b32 v45, 0xffff0000, v115
    v_lshlrev_b32 v90, 16, v116
    v_and_b32 v91, 0xffff0000, v116
    v_lshlrev_b32 v92, 16, v117
    v_and_b32 v93, 0xffff0000, v117
    v_pk_mul_f32 v[118:119], v[42:43], s[6:7]
    v_pk_mul_f32 v[120:121], v[44:45], s[6:7]
    v_exp_f32 v118, v118
    v_exp_f32 v119, v119
    v_exp_f32 v120, v120
    v_exp_f32 v121, v121
    v_pk_add_f32 v[118:119], v[118:119], s[4:5]
    v_pk_add_f32 v[120:121], v[120:121], s[4:5]
    v_rcp_f32 v118, v118
    v_rcp_f32 v119, v119
    v_rcp_f32 v120, v120
    v_rcp_f32 v121, v121
    v_pk_mul_f32 v[42:43], v[42:43], v[118:119]
    v_pk_mul_f32 v[44:45], v[44:45], v[120:121]
    v_cvt_pk_bf16_f32 v114, v42, v43
    v_cvt_pk_bf16_f32 v115, v44, v45
    v_lshlrev_b32 v42, 16, v114
    v_and_b32 v43, 0xffff0000, v114
    v_lshlrev_b32 v44, 16, v115
    v_and_b32 v45, 0xffff0000, v115
    v_pk_mul_f32 v[42:43], v[42:43], v[90:91]
    v_pk_mul_f32 v[44:45], v[44:45], v[92:93]
    v_cvt_pk_bf16_f32 v138, v42, v43
    v_cvt_pk_bf16_f32 v139, v44, v45
    v_cvt_pk_bf16_f32 v122, v46, v47
    v_cvt_pk_bf16_f32 v123, v48, v49
    v_cvt_pk_bf16_f32 v124, v94, v95
    v_cvt_pk_bf16_f32 v125, v96, v97
    v_lshlrev_b32 v46, 16, v122
    v_and_b32 v47, 0xffff0000, v122
    v_lshlrev_b32 v48, 16, v123
    v_and_b32 v49, 0xffff0000, v123
    v_lshlrev_b32 v94, 16, v124
    v_and_b32 v95, 0xffff0000, v124
    v_lshlrev_b32 v96, 16, v125
    v_and_b32 v97, 0xffff0000, v125
    v_pk_mul_f32 v[126:127], v[46:47], s[6:7]
    v_pk_mul_f32 v[128:129], v[48:49], s[6:7]
    v_exp_f32 v126, v126
    v_exp_f32 v127, v127
    v_exp_f32 v128, v128
    v_exp_f32 v129, v129
    v_pk_add_f32 v[126:127], v[126:127], s[4:5]
    v_pk_add_f32 v[128:129], v[128:129], s[4:5]
    v_rcp_f32 v126, v126
    v_rcp_f32 v127, v127
    v_rcp_f32 v128, v128
    v_rcp_f32 v129, v129
    v_pk_mul_f32 v[46:47], v[46:47], v[126:127]
    v_pk_mul_f32 v[48:49], v[48:49], v[128:129]
    v_cvt_pk_bf16_f32 v122, v46, v47
    v_cvt_pk_bf16_f32 v123, v48, v49
    v_lshlrev_b32 v46, 16, v122
    v_and_b32 v47, 0xffff0000, v122
    v_lshlrev_b32 v48, 16, v123
    v_and_b32 v49, 0xffff0000, v123
    v_pk_mul_f32 v[46:47], v[46:47], v[94:95]
    v_pk_mul_f32 v[48:49], v[48:49], v[96:97]
    v_cvt_pk_bf16_f32 v140, v46, v47
    v_cvt_pk_bf16_f32 v141, v48, v49
    s_nop 0
    v_permlane16_swap_b32 v138, v140
    v_permlane16_swap_b32 v139, v141
    s_mov_b32 s8, 294912
    buffer_store_dwordx4 v[138:141], v133, s[20:23], s8 offen offset:64 sc1
L95_done:
    s_mov_b64 exec, -1
    s_lshl_b32 s59, s69, 5
    s_add_u32 s59, s59, s68
    s_mov_b32 s31, s59
    s_load_dwordx2 s[64:65], s[0:1], 48
    s_and_b32 s68, s2, 7
    s_lshr_b32 s69, s2, 3
    s_lshr_b32 s70, s68, 1
    s_and_b32 s68, s68, 1
    s_lshl_b32 s68, s68, 3
    s_lshr_b32 s71, s69, 2
    s_add_u32 s68, s68, s71
    s_and_b32 s69, s69, 3
    s_mul_i32 s63, s3, 16384
    s_lshr_b32 s63, s63, 16
    s_mul_i32 s62, s63, 4
    s_sub_u32 s62, s3, s62
    v_lshrrev_b32 v3, 3, v0
    v_xor_b32 v2, v3, v0
    v_and_b32 v2, 7, v2
    v_lshlrev_b32 v2, 4, v2
    s_mov_b32 s5, 9216
    v_mul_lo_u32 v3, v3, s5
    v_add_u32 v42, v2, v3
    s_add_u32 s4, s3, 0
    s_mul_i32 s5, s4, 73728
    v_add_u32 v2, s5, v42
    s_sub_u32 s5, s4, 16
    s_cmp_ge_u32 s5, 9
    s_cselect_b32 s6, 9, 0
    s_cselect_b32 s7, 36864, 0
    s_sub_u32 s5, s5, s6
    s_cmp_ge_u32 s5, 9
    s_cselect_b32 s6, 9, 0
    s_sub_u32 s5, s5, s6
    s_lshl_b32 s5, s5, 6
    v_add_u32 v3, s5, v0
    v_mul_u32_u24 v4, 3641, v3
    v_lshrrev_b32 v4, 16, v4
    v_mul_u32_u24 v5, 18, v4
    v_sub_u32 v5, v3, v5
    v_lshlrev_b32 v5, 4, v5
    v_and_b32 v6, 0x13, v4
    v_and_b32 v7, 4, v4
    v_lshl_or_b32 v6, v7, 1, v6
    v_and_b32 v7, 8, v4
    v_lshrrev_b32 v7, 1, v7
    v_or_b32 v6, v6, v7
    s_mov_b32 s5, 1152
    v_mul_lo_u32 v6, v6, s5
    v_add3_u32 v5, v5, v6, s7
    s_cmp_lt_u32 s4, 16
    s_cselect_b64 vcc, -1, 0
    v_cndmask_b32 v66, v5, v2, vcc
    s_cselect_b32 s78, 2, 1152
    s_lshl_b32 s78, s78, 6
    s_mov_b32 s72, 0
    s_add_u32 s4, s3, 12
    s_mul_i32 s5, s4, 73728
    v_add_u32 v2, s5, v42
    s_sub_u32 s5, s4, 16
    s_cmp_ge_u32 s5, 9
    s_cselect_b32 s6, 9, 0
    s_cselect_b32 s7, 36864, 0
    s_sub_u32 s5, s5, s6
    s_cmp_ge_u32 s5, 9
    s_cselect_b32 s6, 9, 0
    s_sub_u32 s5, s5, s6
    s_lshl_b32 s5, s5, 6
    v_add_u32 v3, s5, v0
    v_mul_u32_u24 v4, 3641, v3
    v_lshrrev_b32 v4, 16, v4
    v_mul_u32_u24 v5, 18, v4
    v_sub_u32 v5, v3, v5
    v_lshlrev_b32 v5, 4, v5
    v_and_b32 v6, 0x13, v4
    v_and_b32 v7, 4, v4
    v_lshl_or_b32 v6, v7, 1, v6
    v_and_b32 v7, 8, v4
    v_lshrrev_b32 v7, 1, v7
    v_or_b32 v6, v6, v7
    s_mov_b32 s5, 1152
    v_mul_lo_u32 v6, v6, s5
    v_add3_u32 v5, v5, v6, s7
    s_cmp_lt_u32 s4, 16
    s_cselect_b64 vcc, -1, 0
    v_cndmask_b32 v67, v5, v2, vcc
    s_cselect_b32 s79, 2, 1152
    s_lshl_b32 s79, s79, 6
    s_mov_b32 s73, 0
    s_add_u32 s4, s3, 24
    s_mul_i32 s5, s4, 73728
    v_add_u32 v2, s5, v42
    s_sub_u32 s5, s4, 16
    s_cmp_ge_u32 s5, 9
    s_cselect_b32 s6, 9, 0
    s_cselect_b32 s7, 36864, 0
    s_sub_u32 s5, s5, s6
    s_cmp_ge_u32 s5, 9
    s_cselect_b32 s6, 9, 0
    s_sub_u32 s5, s5, s6
    s_lshl_b32 s5, s5, 6
    v_add_u32 v3, s5, v0
    v_mul_u32_u24 v4, 3641, v3
    v_lshrrev_b32 v4, 16, v4
    v_mul_u32_u24 v5, 18, v4
    v_sub_u32 v5, v3, v5
    v_lshlrev_b32 v5, 4, v5
    v_and_b32 v6, 0x13, v4
    v_and_b32 v7, 4, v4
    v_lshl_or_b32 v6, v7, 1, v6
    v_and_b32 v7, 8, v4
    v_lshrrev_b32 v7, 1, v7
    v_or_b32 v6, v6, v7
    s_mov_b32 s5, 1152
    v_mul_lo_u32 v6, v6, s5
    v_add3_u32 v5, v5, v6, s7
    s_cmp_lt_u32 s4, 16
    s_cselect_b64 vcc, -1, 0
    v_cndmask_b32 v68, v5, v2, vcc
    s_cselect_b32 s80, 2, 1152
    s_lshl_b32 s80, s80, 6
    s_mov_b32 s74, 0
    s_cmp_ge_u32 s4, 34
    s_cselect_b32 s57, 1, 0
    v_lshrrev_b32 v3, 4, v0
    v_xor_b32 v2, v3, v0
    v_and_b32 v2, 7, v2
    v_lshlrev_b32 v2, 4, v2
    v_and_b32 v3, 15, v0
    v_lshl_add_u32 v2, v3, 7, v2
    s_mul_i32 s4, s62, 4096
    v_add_u32 v2, s4, v2
    v_xor_b32 v3, 64, v2
    v_add_u32 v54, 0, v2
    v_add_u32 v55, 0, v3
    v_add_u32 v56, 34816, v2
    v_add_u32 v57, 34816, v3
    v_add_u32 v58, 69632, v2
    v_add_u32 v59, 69632, v3
    v_add_u32 v60, 104448, v2
    v_add_u32 v61, 104448, v3
    v_lshrrev_b32 v3, 5, v0
    v_lshlrev_b32 v3, 4, v3
    v_bfe_u32 v4, v0, 4, 1
    v_lshl_add_u32 v3, v4, 2, v3
    v_bfe_u32 v4, v0, 2, 2
    v_add_u32 v3, v3, v4
    v_and_b32 v5, 3, v0
    v_lshlrev_b32 v5, 3, v5
    v_mul_u32_u24 v6, 288, v3
    v_add_u32 v6, v6, v5
    s_mul_i32 s4, s63, 96
    v_add_u32 v6, s4, v6
    v_add_u32 v62, 16384, v6
    v_add_u32 v63, 51200, v6
    v_add_u32 v64, 86016, v6
    v_add_u32 v65, 120832, v6
    s_waitcnt lgkmcnt(0)
    s_mul_i32 s6, s68, 1179648
    s_mul_i32 s7, s70, 2304
    s_add_u32 s6, s6, s7
    s_add_u32 s7, s6, 16777216
    s_add_u32 s8, s28, s7
    s_addc_u32 s9, s29, 0
    s_and_b32 s9, s9, 0xffff
    s_mov_b32 s10, 0
    s_mov_b32 s11, 0x00020000
    s_sub_u32 s10, 18874368, s6
    s_mul_i32 s6, s70, 1327104
    s_mul_i32 s7, s69, 288
    s_add_u32 s6, s6, s7
    s_add_u32 s12, s64, s6
    s_addc_u32 s13, s65, 0
    s_and_b32 s13, s13, 0xffff
    s_mov_b32 s14, 0
    s_mov_b32 s15, 0x00020000
    s_sub_u32 s14, 5308416, s6
    s_mov_b32 s16, s12
    s_mov_b32 s17, s13
    s_mov_b32 s18, s14
    s_mov_b32 s19, s15
    s_add_u32 s20, s28, 37748736
    s_addc_u32 s21, s29, 0
    s_and_b32 s21, s21, 0xffff
    s_mov_b32 s22, 18874368
    s_mov_b32 s23, 0x00020000
    s_add_u32 s4, s3, 0
    s_sub_u32 s5, s4, 16
    s_cmp_ge_u32 s5, 9
    s_cselect_b32 s6, 9, 0
    s_sub_u32 s5, s5, s6
    s_cmp_ge_u32 s5, 9
    s_cselect_b32 s32, s16, s12
    s_cselect_b32 s33, s17, s13
    s_cselect_b32 s34, s18, s14
    s_cselect_b32 s35, s19, s15
    s_cmp_lt_u32 s4, 16
    s_cselect_b32 s32, s8, s32
    s_cselect_b32 s33, s9, s33
    s_cselect_b32 s34, s10, s34
    s_cselect_b32 s35, s11, s35
    s_add_u32 s4, s3, 12
    s_sub_u32 s5, s4, 16
    s_cmp_ge_u32 s5, 9
    s_cselect_b32 s6, 9, 0
    s_sub_u32 s5, s5, s6
    s_cmp_ge_u32 s5, 9
    s_cselect_b32 s36, s16, s12
    s_cselect_b32 s37, s17, s13
    s_cselect_b32 s38, s18, s14
    s_cselect_b32 s39, s19, s15
    s_cmp_lt_u32 s4, 16
    s_cselect_b32 s36, s8, s36
    s_cselect_b32 s37, s9, s37
    s_cselect_b32 s38, s10, s38
    s_cselect_b32 s39, s11, s39
    s_add_u32 s4, s3, 24
    s_sub_u32 s5, s4, 16
    s_cmp_ge_u32 s5, 9
    s_cselect_b32 s6, 9, 0
    s_sub_u32 s5, s5, s6
    s_cmp_ge_u32 s5, 9
    s_cselect_b32 s40, s16, s12
    s_cselect_b32 s41, s17, s13
    s_cselect_b32 s42, s18, s14
    s_cselect_b32 s43, s19, s15
    s_cmp_lt_u32 s4, 16
    s_cselect_b32 s40, s8, s40
    s_cselect_b32 s41, s9, s41
    s_cselect_b32 s42, s10, s42
    s_cselect_b32 s43, s11, s43
    s_waitcnt vmcnt(0)
    s_barrier
    s_cmp_lg_u32 s3, 0
    s_cbranch_scc1 L104_pub
    s_lshl_b32 s4, s31, 7
    s_add_u32 s4, s4, 196608
    s_add_u32 s4, s4, s99
    v_mov_b32 v1, s4
    v_mov_b32 v2, s100
    v_mov_b32 v3, s101
    s_mov_b64 exec, 1
    buffer_store_dwordx2 v[2:3], v1, s[88:91], 0 offen sc1
    s_mov_b64 exec, -1
L104_pub:
L103_nopp:
    s_add_u32 s4, s3, 0
    s_cmp_lt_u32 s4, 16
    s_cbranch_scc1 L105_t
    s_add_u32 m0, s56, 0
    s_nop 0
    buffer_load_dwordx4 v66, s[32:35], s72 offen lds
    s_add_u32 s72, s72, s78
    s_add_u32 m0, s56, 34816
    s_nop 0
    buffer_load_dwordx4 v66, s[32:35], s72 offen lds
    s_add_u32 s72, s72, s78
    s_add_u32 m0, s56, 69632
    s_nop 0
    buffer_load_dwordx4 v66, s[32:35], s72 offen lds
    s_add_u32 s72, s72, s78
    s_add_u32 m0, s56, 104448
    s_nop 0
    buffer_load_dwordx4 v66, s[32:35], s72 offen lds
    s_add_u32 s72, s72, s78
L105_t:
    s_add_u32 s4, s3, 12
    s_cmp_lt_u32 s4, 16
    s_cbranch_scc1 L106_t
    s_add_u32 m0, s56, 12288
    s_nop 0
    buffer_load_dwordx4 v67, s[36:39], s73 offen lds
    s_add_u32 s73, s73, s79
    s_add_u32 m0, s56, 47104
    s_nop 0
    buffer_load_dwordx4 v67, s[36:39], s73 offen lds
    s_add_u32 s73, s73, s79
    s_add_u32 m0, s56, 81920
    s_nop 0
    buffer_load_dwordx4 v67, s[36:39], s73 offen lds
    s_add_u32 s73, s73, s79
    s_add_u32 m0, s56, 116736
    s_nop 0
    buffer_load_dwordx4 v67, s[36:39], s73 offen lds
    s_add_u32 s73, s73, s79
L106_t:
    s_add_u32 s4, s3, 24
    s_cmp_lt_u32 s4, 16
    s_cbranch_scc1 L107_t
    s_cmp_eq_u32 s57, 1
    s_cbranch_scc1 L108_d
    s_add_u32 m0, s56, 24576
    s_nop 0
    buffer_load_dwordx4 v68, s[40:43], s74 offen lds
    s_add_u32 s74, s74, s80
L108_d:
    s_cmp_eq_u32 s57, 1
    s_cbranch_scc1 L109_d
    s_add_u32 m0, s56, 59392
    s_nop 0
    buffer_load_dwordx4 v68, s[40:43], s74 offen lds
    s_add_u32 s74, s74, s80
L109_d:
    s_cmp_eq_u32 s57, 1
    s_cbranch_scc1 L110_d
    s_add_u32 m0, s56, 94208
    s_nop 0
    buffer_load_dwordx4 v68, s[40:43], s74 offen lds
    s_add_u32 s74, s74, s80
L110_d:
    s_cmp_eq_u32 s57, 1
    s_cbranch_scc1 L111_d
    s_add_u32 m0, s56, 129024
    s_nop 0
    buffer_load_dwordx4 v68, s[40:43], s74 offen lds
    s_add_u32 s74, s74, s80
L111_d:
L107_t:
    s_lshr_b32 s59, s68, 1
    s_lshl_b32 s59, s59, 5
    s_lshl_b32 s4, s70, 3
    s_add_u32 s59, s59, s4
    s_cmp_lg_u32 s3, 0
    s_cbranch_scc1 L112_polln
    s_mov_b32 s6, 255
    s_mov_b32 s7, 0
    s_mov_b64 exec, s[6:7]
    v_add_u32 v1, s59, v0
    v_lshlrev_b32 v1, 7, v1
    v_add_u32 v1, 196608, v1
    v_add_u32 v1, s99, v1
    s_mov_b32 s5, 0
L112_poll:
    buffer_load_dwordx2 v[2:3], v1, s[88:91], 0 offen sc1
    s_waitcnt vmcnt(0)
    v_cmp_ne_u64 vcc, s[100:101], v[2:3]
    s_add_u32 s5, s5, 1
    s_cmp_gt_u32 s5, 0x40000
    s_cbranch_scc1 L112_pollx
    s_cbranch_vccz L112_pollx
    s_sleep 1
    s_branch L112_poll
L112_pollx:
    s_mov_b64 exec, -1
L112_polln:
    s_barrier
    s_cmp_ge_u32 s3, 16
    s_cbranch_scc1 L113_ta
    s_add_u32 m0, s56, 0
    s_nop 0
    buffer_load_dwordx4 v66, s[32:35], s72 offen lds
    s_add_u32 s72, s72, s78
L113_ta:
    s_cmp_ge_u32 s3, 4
    s_cbranch_scc1 L114_ta
    s_add_u32 m0, s56, 12288
    s_nop 0
    buffer_load_dwordx4 v67, s[36:39], s73 offen lds
    s_add_u32 s73, s73, s79
L114_ta:
    s_cmp_ge_u32 s3, 16
    s_cbranch_scc1 L115_ta
    s_add_u32 m0, s56, 34816
    s_nop 0
    buffer_load_dwordx4 v66, s[32:35], s72 offen lds
    s_add_u32 s72, s72, s78
L115_ta:
    s_cmp_ge_u32 s3, 4
    s_cbranch_scc1 L116_ta
    s_add_u32 m0, s56, 47104
    s_nop 0
    buffer_load_dwordx4 v67, s[36:39], s73 offen lds
    s_add_u32 s73, s73, s79
L116_ta:
    s_cmp_ge_u32 s3, 16
    s_cbranch_scc1 L117_ta
    s_add_u32 m0, s56, 69632
    s_nop 0
    buffer_load_dwordx4 v66, s[32:35], s72 offen lds
    s_add_u32 s72, s72, s78
L117_ta:
    s_cmp_ge_u32 s3, 4
    s_cbranch_scc1 L118_ta
    s_add_u32 m0, s56, 81920
    s_nop 0
    buffer_load_dwordx4 v67, s[36:39], s73 offen lds
    s_add_u32 s73, s73, s79
L118_ta:
    s_cmp_ge_u32 s3, 16
    s_cbranch_scc1 L119_ta
    s_add_u32 m0, s56, 104448
    s_nop 0
    buffer_load_dwordx4 v66, s[32:35], s72 offen lds
    s_add_u32 s72, s72, s78
L119_ta:
    s_cmp_ge_u32 s3, 4
    s_cbranch_scc1 L120_ta
    s_add_u32 m0, s56, 116736
    s_nop 0
    buffer_load_dwordx4 v67, s[36:39], s73 offen lds
    s_add_u32 s73, s73, s79
L120_ta:
    s_cmp_ge_u32 s3, 4
    s_cbranch_scc1 L121_awa
    s_waitcnt vmcnt(6)
    s_branch L121_awb
L121_awa:
    s_waitcnt vmcnt(3)
L121_awb:
    s_barrier
    ds_read_b128 v[26:29], v54 offset:0
    ds_read_b128 v[30:33], v54 offset:2048
    ds_read_b64_tr_b16 v[42:43], v62 offset:0
    ds_read_b64_tr_b16 v[44:45], v62 offset:2304
    ds_read_b64_tr_b16 v[46:47], v62 offset:32
    ds_read_b64_tr_b16 v[48:49], v62 offset:2336
    ds_read_b64_tr_b16 v[50:51], v62 offset:64
    ds_read_b64_tr_b16 v[52:53], v62 offset:2368
    ds_read_b128 v[34:37], v55 offset:0
    ds_read_b128 v[38:41], v55 offset:2048
    s_waitcnt lgkmcnt(6)
    v_mfma_f32_16x16x32_bf16 v[2:5], v[42:45], v[26:29], 0
    v_mfma_f32_16x16x32_bf16 v[6:9], v[42:45], v[30:33], 0
    ds_read_b64_tr_b16 v[42:43], v62 offset:9216
    ds_read_b64_tr_b16 v[44:45], v62 offset:11520
    s_waitcnt lgkmcnt(6)
    v_mfma_f32_16x16x32_bf16 v[10:13], v[46:49], v[26:29], 0
    v_mfma_f32_16x16x32_bf16 v[14:17], v[46:49], v[30:33], 0
    ds_read_b64_tr_b16 v[46:47], v62 offset:9248
    ds_read_b64_tr_b16 v[48:49], v62 offset:11552
    s_waitcnt lgkmcnt(6)
    v_mfma_f32_16x16x32_bf16 v[18:21], v[50:53], v[26:29], 0
    v_mfma_f32_16x16x32_bf16 v[22:25], v[50:53], v[30:33], 0
    ds_read_b64_tr_b16 v[50:51], v62 offset:9280
    ds_read_b64_tr_b16 v[52:53], v62 offset:11584
    s_waitcnt lgkmcnt(0)
    s_waitcnt vmcnt(0)
    s_barrier
    ds_read_b128 v[26:29], v56 offset:0
    ds_read_b128 v[30:33], v56 offset:2048
    s_waitcnt lgkmcnt(6)
    v_mfma_f32_16x16x32_bf16 v[2:5], v[42:45], v[34:37], v[2:5]
    v_mfma_f32_16x16x32_bf16 v[6:9], v[42:45], v[38:41], v[6:9]
    ds_read_b64_tr_b16 v[42:43], v63 offset:0
    ds_read_b64_tr_b16 v[44:45], v63 offset:2304
    s_add_u32 m0, s56, 0
    s_nop 0
    buffer_load_dwordx4 v66, s[32:35], s72 offen lds
    s_add_u32 s72, s72, s78
    s_waitcnt lgkmcnt(6)
    v_mfma_f32_16x16x32_bf16 v[10:13], v[46:49], v[34:37], v[10:13]
    v_mfma_f32_16x16x32_bf16 v[14:17], v[46:49], v[38:41], v[14:17]
    ds_read_b64_tr_b16 v[46:47], v63 offset:32
    ds_read_b64_tr_b16 v[48:49], v63 offset:2336
    s_add_u32 m0, s56, 12288
    s_nop 0
    buffer_load_dwordx4 v67, s[36:39], s73 offen lds
    s_add_u32 s73, s73, s79
    s_waitcnt lgkmcnt(6)
    v_mfma_f32_16x16x32_bf16 v[18:21], v[50:53], v[34:37], v[18:21]
    v_mfma_f32_16x16x32_bf16 v[22:25], v[50:53], v[38:41], v[22:25]
    ds_read_b64_tr_b16 v[50:51], v63 offset:64
    ds_read_b64_tr_b16 v[52:53], v63 offset:2368
    s_cmp_eq_u32 s57, 1
    s_cbranch_scc1 L123_d
    s_add_u32 m0, s56, 24576
    s_nop 0
    buffer_load_dwordx4 v68, s[40:43], s74 offen lds
    s_add_u32 s74, s74, s80
L123_d:
    ds_read_b128 v[34:37], v57 offset:0
    ds_read_b128 v[38:41], v57 offset:2048
    s_waitcnt lgkmcnt(6)
    v_mfma_f32_16x16x32_bf16 v[2:5], v[42:45], v[26:29], v[2:5]
    v_mfma_f32_16x16x32_bf16 v[6:9], v[42:45], v[30:33], v[6:9]
    ds_read_b64_tr_b16 v[42:43], v63 offset:9216
    ds_read_b64_tr_b16 v[44:45], v63 offset:11520
    s_waitcnt lgkmcnt(6)
    v_mfma_f32_16x16x32_bf16 v[10:13], v[46:49], v[26:29], v[10:13]
    v_mfma_f32_16x16x32_bf16 v[14:17], v[46:49], v[30:33], v[14:17]
    ds_read_b64_tr_b16 v[46:47], v63 offset:9248
    ds_read_b64_tr_b16 v[48:49], v63 offset:11552
    s_waitcnt lgkmcnt(6)
    v_mfma_f32_16x16x32_bf16 v[18:21], v[50:53], v[26:29], v[18:21]
    v_mfma_f32_16x16x32_bf16 v[22:25], v[50:53], v[30:33], v[22:25]
    ds_read_b64_tr_b16 v[50:51], v63 offset:9280
    ds_read_b64_tr_b16 v[52:53], v63 offset:11584
    s_waitcnt lgkmcnt(0)
    s_barrier
    ds_read_b128 v[26:29], v58 offset:0
    ds_read_b128 v[30:33], v58 offset:2048
    s_waitcnt lgkmcnt(6)
    v_mfma_f32_16x16x32_bf16 v[2:5], v[42:45], v[34:37], v[2:5]
    v_mfma_f32_16x16x32_bf16 v[6:9], v[42:45], v[38:41], v[6:9]
    ds_read_b64_tr_b16 v[42:43], v64 offset:0
    ds_read_b64_tr_b16 v[44:45], v64 offset:2304
    s_add_u32 m0, s56, 34816
    s_nop 0
    buffer_load_dwordx4 v66, s[32:35], s72 offen lds
    s_add_u32 s72, s72, s78
    s_waitcnt lgkmcnt(6)
    v_mfma_f32_16x16x32_bf16 v[10:13], v[46:49], v[34:37], v[10:13]
    v_mfma_f32_16x16x32_bf16 v[14:17], v[46:49], v[38:41], v[14:17]
    ds_read_b64_tr_b16 v[46:47], v64 offset:32
    ds_read_b64_tr_b16 v[48:49], v64 offset:2336
    s_add_u32 m0, s56, 47104
    s_nop 0
    buffer_load_dwordx4 v67, s[36:39], s73 offen lds
    s_add_u32 s73, s73, s79
    s_waitcnt lgkmcnt(6)
    v_mfma_f32_16x16x32_bf16 v[18:21], v[50:53], v[34:37], v[18:21]
    v_mfma_f32_16x16x32_bf16 v[22:25], v[50:53], v[38:41], v[22:25]
    ds_read_b64_tr_b16 v[50:51], v64 offset:64
    ds_read_b64_tr_b16 v[52:53], v64 offset:2368
    s_cmp_eq_u32 s57, 1
    s_cbranch_scc1 L124_d
    s_add_u32 m0, s56, 59392
    s_nop 0
    buffer_load_dwordx4 v68, s[40:43], s74 offen lds
    s_add_u32 s74, s74, s80
L124_d:
    ds_read_b128 v[34:37], v59 offset:0
    ds_read_b128 v[38:41], v59 offset:2048
    s_waitcnt lgkmcnt(6)
    v_mfma_f32_16x16x32_bf16 v[2:5], v[42:45], v[26:29], v[2:5]
    v_mfma_f32_16x16x32_bf16 v[6:9], v[42:45], v[30:33], v[6:9]
    ds_read_b64_tr_b16 v[42:43], v64 offset:9216
    ds_read_b64_tr_b16 v[44:45], v64 offset:11520
    s_waitcnt lgkmcnt(6)
    v_mfma_f32_16x16x32_bf16 v[10:13], v[46:49], v[26:29], v[10:13]
    v_mfma_f32_16x16x32_bf16 v[14:17], v[46:49], v[30:33], v[14:17]
    ds_read_b64_tr_b16 v[46:47], v64 offset:9248
    ds_read_b64_tr_b16 v[48:49], v64 offset:11552
    s_waitcnt lgkmcnt(6)
    v_mfma_f32_16x16x32_bf16 v[18:21], v[50:53], v[26:29], v[18:21]
    v_mfma_f32_16x16x32_bf16 v[22:25], v[50:53], v[30:33], v[22:25]
    ds_read_b64_tr_b16 v[50:51], v64 offset:9280
    ds_read_b64_tr_b16 v[52:53], v64 offset:11584
    s_waitcnt lgkmcnt(0)
    s_barrier
    ds_read_b128 v[26:29], v60 offset:0
    ds_read_b128 v[30:33], v60 offset:2048
    s_waitcnt lgkmcnt(6)
    v_mfma_f32_16x16x32_bf16 v[2:5], v[42:45], v[34:37], v[2:5]
    v_mfma_f32_16x16x32_bf16 v[6:9], v[42:45], v[38:41], v[6:9]
    ds_read_b64_tr_b16 v[42:43], v65 offset:0
    ds_read_b64_tr_b16 v[44:45], v65 offset:2304
    s_add_u32 m0, s56, 69632
    s_nop 0
    buffer_load_dwordx4 v66, s[32:35], s72 offen lds
    s_add_u32 s72, s72, s78
    s_waitcnt lgkmcnt(6)
    v_mfma_f32_16x16x32_bf16 v[10:13], v[46:49], v[34:37], v[10:13]
    v_mfma_f32_16x16x32_bf16 v[14:17], v[46:49], v[38:41], v[14:17]
    ds_read_b64_tr_b16 v[46:47], v65 offset:32
    ds_read_b64_tr_b16 v[48:49], v65 offset:2336
    s_add_u32 m0, s56, 81920
    s_nop 0
    buffer_load_dwordx4 v67, s[36:39], s73 offen lds
    s_add_u32 s73, s73, s79
    s_waitcnt lgkmcnt(6)
    v_mfma_f32_16x16x32_bf16 v[18:21], v[50:53], v[34:37], v[18:21]
    v_mfma_f32_16x16x32_bf16 v[22:25], v[50:53], v[38:41], v[22:25]
    ds_read_b64_tr_b16 v[50:51], v65 offset:64
    ds_read_b64_tr_b16 v[52:53], v65 offset:2368
    s_cmp_eq_u32 s57, 1
    s_cbranch_scc1 L125_d
    s_add_u32 m0, s56, 94208
    s_nop 0
    buffer_load_dwordx4 v68, s[40:43], s74 offen lds
    s_add_u32 s74, s74, s80
L125_d:
    ds_read_b128 v[34:37], v61 offset:0
    ds_read_b128 v[38:41], v61 offset:2048
    s_waitcnt lgkmcnt(6)
    v_mfma_f32_16x16x32_bf16 v[2:5], v[42:45], v[26:29], v[2:5]
    v_mfma_f32_16x16x32_bf16 v[6:9], v[42:45], v[30:33], v[6:9]
    ds_read_b64_tr_b16 v[42:43], v65 offset:9216
    ds_read_b64_tr_b16 v[44:45], v65 offset:11520
    s_waitcnt lgkmcnt(6)
    v_mfma_f32_16x16x32_bf16 v[10:13], v[46:49], v[26:29], v[10:13]
    v_mfma_f32_16x16x32_bf16 v[14:17], v[46:49], v[30:33], v[14:17]
    ds_read_b64_tr_b16 v[46:47], v65 offset:9248
    ds_read_b64_tr_b16 v[48:49], v65 offset:11552
    s_waitcnt lgkmcnt(6)
    v_mfma_f32_16x16x32_bf16 v[18:21], v[50:53], v[26:29], v[18:21]
    v_mfma_f32_16x16x32_bf16 v[22:25], v[50:53], v[30:33], v[22:25]
    ds_read_b64_tr_b16 v[50:51], v65 offset:9280
    ds_read_b64_tr_b16 v[52:53], v65 offset:11584
    s_waitcnt lgkmcnt(0)
    s_cmp_eq_u32 s57, 1
    s_cbranch_scc1 L126_wa
    s_waitcnt vmcnt(6)
    s_branch L126_wb
L126_wa:
    s_waitcnt vmcnt(4)
L126_wb:
    s_barrier
    ds_read_b128 v[26:29], v54 offset:0
    ds_read_b128 v[30:33], v54 offset:2048
    s_waitcnt lgkmcnt(6)
    v_mfma_f32_16x16x32_bf16 v[2:5], v[42:45], v[34:37], v[2:5]
    v_mfma_f32_16x16x32_bf16 v[6:9], v[42:45], v[38:41], v[6:9]
    ds_read_b64_tr_b16 v[42:43], v62 offset:0
    ds_read_b64_tr_b16 v[44:45], v62 offset:2304
    s_add_u32 m0, s56, 104448
    s_nop 0
    buffer_load_dwordx4 v66, s[32:35], s72 offen lds
    s_add_u32 s72, s72, s78
    s_waitcnt lgkmcnt(6)
    v_mfma_f32_16x16x32_bf16 v[10:13], v[46:49], v[34:37], v[10:13]
    v_mfma_f32_16x16x32_bf16 v[14:17], v[46:49], v[38:41], v[14:17]
    ds_read_b64_tr_b16 v[46:47], v62 offset:32
    ds_read_b64_tr_b16 v[48:49], v62 offset:2336
    s_add_u32 m0, s56, 116736
    s_nop 0
    buffer_load_dwordx4 v67, s[36:39], s73 offen lds
    s_add_u32 s73, s73, s79
    s_waitcnt lgkmcnt(6)
    v_mfma_f32_16x16x32_bf16 v[18:21], v[50:53], v[34:37], v[18:21]
    v_mfma_f32_16x16x32_bf16 v[22:25], v[50:53], v[38:41], v[22:25]
    ds_read_b64_tr_b16 v[50:51], v62 offset:64
    ds_read_b64_tr_b16 v[52:53], v62 offset:2368
    s_cmp_eq_u32 s57, 1
    s_cbranch_scc1 L127_d
    s_add_u32 m0, s56, 129024
    s_nop 0
    buffer_load_dwordx4 v68, s[40:43], s74 offen lds
    s_add_u32 s74, s74, s80
L127_d:
    ds_read_b128 v[34:37], v55 offset:0
    ds_read_b128 v[38:41], v55 offset:2048
    s_waitcnt lgkmcnt(6)
    v_mfma_f32_16x16x32_bf16 v[2:5], v[42:45], v[26:29], v[2:5]
    v_mfma_f32_16x16x32_bf16 v[6:9], v[42:45], v[30:33], v[6:9]
    ds_read_b64_tr_b16 v[42:43], v62 offset:9216
    ds_read_b64_tr_b16 v[44:45], v62 offset:11520
    s_waitcnt lgkmcnt(6)
    v_mfma_f32_16x16x32_bf16 v[10:13], v[46:49], v[26:29], v[10:13]
    v_mfma_f32_16x16x32_bf16 v[14:17], v[46:49], v[30:33], v[14:17]
    ds_read_b64_tr_b16 v[46:47], v62 offset:9248
    ds_read_b64_tr_b16 v[48:49], v62 offset:11552
    s_waitcnt lgkmcnt(6)
    v_mfma_f32_16x16x32_bf16 v[18:21], v[50:53], v[26:29], v[18:21]
    v_mfma_f32_16x16x32_bf16 v[22:25], v[50:53], v[30:33], v[22:25]
    ds_read_b64_tr_b16 v[50:51], v62 offset:9280
    ds_read_b64_tr_b16 v[52:53], v62 offset:11584
    s_waitcnt lgkmcnt(0)
    s_cmp_eq_u32 s57, 1
    s_cbranch_scc1 L128_wa
    s_waitcnt vmcnt(6)
    s_branch L128_wb
L128_wa:
    s_waitcnt vmcnt(4)
L128_wb:
    s_barrier
    ds_read_b128 v[26:29], v56 offset:0
    ds_read_b128 v[30:33], v56 offset:2048
    s_waitcnt lgkmcnt(6)
    v_mfma_f32_16x16x32_bf16 v[2:5], v[42:45], v[34:37], v[2:5]
    v_mfma_f32_16x16x32_bf16 v[6:9], v[42:45], v[38:41], v[6:9]
    ds_read_b64_tr_b16 v[42:43], v63 offset:0
    ds_read_b64_tr_b16 v[44:45], v63 offset:2304
    s_add_u32 m0, s56, 0
    s_nop 0
    buffer_load_dwordx4 v66, s[32:35], s72 offen lds
    s_add_u32 s72, s72, s78
    s_waitcnt lgkmcnt(6)
    v_mfma_f32_16x16x32_bf16 v[10:13], v[46:49], v[34:37], v[10:13]
    v_mfma_f32_16x16x32_bf16 v[14:17], v[46:49], v[38:41], v[14:17]
    ds_read_b64_tr_b16 v[46:47], v63 offset:32
    ds_read_b64_tr_b16 v[48:49], v63 offset:2336
    s_add_u32 m0, s56, 12288
    s_nop 0
    buffer_load_dwordx4 v67, s[36:39], s73 offen lds
    s_add_u32 s73, s73, s79
    s_waitcnt lgkmcnt(6)
    v_mfma_f32_16x16x32_bf16 v[18:21], v[50:53], v[34:37], v[18:21]
    v_mfma_f32_16x16x32_bf16 v[22:25], v[50:53], v[38:41], v[22:25]
    ds_read_b64_tr_b16 v[50:51], v63 offset:64
    ds_read_b64_tr_b16 v[52:53], v63 offset:2368
    s_cmp_eq_u32 s57, 1
    s_cbranch_scc1 L129_d
    s_add_u32 m0, s56, 24576
    s_nop 0
    buffer_load_dwordx4 v68, s[40:43], s74 offen lds
    s_add_u32 s74, s74, s80
L129_d:
    ds_read_b128 v[34:37], v57 offset:0
    ds_read_b128 v[38:41], v57 offset:2048
    s_waitcnt lgkmcnt(6)
    v_mfma_f32_16x16x32_bf16 v[2:5], v[42:45], v[26:29], v[2:5]
    v_mfma_f32_16x16x32_bf16 v[6:9], v[42:45], v[30:33], v[6:9]
    ds_read_b64_tr_b16 v[42:43], v63 offset:9216
    ds_read_b64_tr_b16 v[44:45], v63 offset:11520
    s_waitcnt lgkmcnt(6)
    v_mfma_f32_16x16x32_bf16 v[10:13], v[46:49], v[26:29], v[10:13]
    v_mfma_f32_16x16x32_bf16 v[14:17], v[46:49], v[30:33], v[14:17]
    ds_read_b64_tr_b16 v[46:47], v63 offset:9248
    ds_read_b64_tr_b16 v[48:49], v63 offset:11552
    s_waitcnt lgkmcnt(6)
    v_mfma_f32_16x16x32_bf16 v[18:21], v[50:53], v[26:29], v[18:21]
    v_mfma_f32_16x16x32_bf16 v[22:25], v[50:53], v[30:33], v[22:25]
    ds_read_b64_tr_b16 v[50:51], v63 offset:9280
    ds_read_b64_tr_b16 v[52:53], v63 offset:11584
    s_waitcnt lgkmcnt(0)
    s_cmp_eq_u32 s57, 1
    s_cbranch_scc1 L130_wa
    s_waitcnt vmcnt(6)
    s_branch L130_wb
L130_wa:
    s_waitcnt vmcnt(4)
L130_wb:
    s_barrier
    ds_read_b128 v[26:29], v58 offset:0
    ds_read_b128 v[30:33], v58 offset:2048
    s_waitcnt lgkmcnt(6)
    v_mfma_f32_16x16x32_bf16 v[2:5], v[42:45], v[34:37], v[2:5]
    v_mfma_f32_16x16x32_bf16 v[6:9], v[42:45], v[38:41], v[6:9]
    ds_read_b64_tr_b16 v[42:43], v64 offset:0
    ds_read_b64_tr_b16 v[44:45], v64 offset:2304
    s_add_u32 m0, s56, 34816
    s_nop 0
    buffer_load_dwordx4 v66, s[32:35], s72 offen lds
    s_add_u32 s72, s72, s78
    s_waitcnt lgkmcnt(6)
    v_mfma_f32_16x16x32_bf16 v[10:13], v[46:49], v[34:37], v[10:13]
    v_mfma_f32_16x16x32_bf16 v[14:17], v[46:49], v[38:41], v[14:17]
    ds_read_b64_tr_b16 v[46:47], v64 offset:32
    ds_read_b64_tr_b16 v[48:49], v64 offset:2336
    s_add_u32 m0, s56, 47104
    s_nop 0
    buffer_load_dwordx4 v67, s[36:39], s73 offen lds
    s_add_u32 s73, s73, s79
    s_waitcnt lgkmcnt(6)
    v_mfma_f32_16x16x32_bf16 v[18:21], v[50:53], v[34:37], v[18:21]
    v_mfma_f32_16x16x32_bf16 v[22:25], v[50:53], v[38:41], v[22:25]
    ds_read_b64_tr_b16 v[50:51], v64 offset:64
    ds_read_b64_tr_b16 v[52:53], v64 offset:2368
    s_cmp_eq_u32 s57, 1
    s_cbranch_scc1 L131_d
    s_add_u32 m0, s56, 59392
    s_nop 0
    buffer_load_dwordx4 v68, s[40:43], s74 offen lds
    s_add_u32 s74, s74, s80
L131_d:
    ds_read_b128 v[34:37], v59 offset:0
    ds_read_b128 v[38:41], v59 offset:2048
    s_waitcnt lgkmcnt(6)
    v_mfma_f32_16x16x32_bf16 v[2:5], v[42:45], v[26:29], v[2:5]
    v_mfma_f32_16x16x32_bf16 v[6:9], v[42:45], v[30:33], v[6:9]
    ds_read_b64_tr_b16 v[42:43], v64 offset:9216
    ds_read_b64_tr_b16 v[44:45], v64 offset:11520
    s_waitcnt lgkmcnt(6)
    v_mfma_f32_16x16x32_bf16 v[10:13], v[46:49], v[26:29], v[10:13]
    v_mfma_f32_16x16x32_bf16 v[14:17], v[46:49], v[30:33], v[14:17]
    ds_read_b64_tr_b16 v[46:47], v64 offset:9248
    ds_read_b64_tr_b16 v[48:49], v64 offset:11552
    s_waitcnt lgkmcnt(6)
    v_mfma_f32_16x16x32_bf16 v[18:21], v[50:53], v[26:29], v[18:21]
    v_mfma_f32_16x16x32_bf16 v[22:25], v[50:53], v[30:33], v[22:25]
    ds_read_b64_tr_b16 v[50:51], v64 offset:9280
    ds_read_b64_tr_b16 v[52:53], v64 offset:11584
    s_waitcnt lgkmcnt(0)
    s_cmp_eq_u32 s57, 1
    s_cbranch_scc1 L132_wa
    s_waitcnt vmcnt(6)
    s_branch L132_wb
L132_wa:
    s_waitcnt vmcnt(4)
L132_wb:
    s_barrier
    ds_read_b128 v[26:29], v60 offset:0
    ds_read_b128 v[30:33], v60 offset:2048
    s_waitcnt lgkmcnt(6)
    v_mfma_f32_16x16x32_bf16 v[2:5], v[42:45], v[34:37], v[2:5]
    v_mfma_f32_16x16x32_bf16 v[6:9], v[42:45], v[38:41], v[6:9]
    ds_read_b64_tr_b16 v[42:43], v65 offset:0
    ds_read_b64_tr_b16 v[44:45], v65 offset:2304
    s_add_u32 m0, s56, 69632
    s_nop 0
    buffer_load_dwordx4 v66, s[32:35], s72 offen lds
    s_add_u32 s72, s72, s78
    s_waitcnt lgkmcnt(6)
    v_mfma_f32_16x16x32_bf16 v[10:13], v[46:49], v[34:37], v[10:13]
    v_mfma_f32_16x16x32_bf16 v[14:17], v[46:49], v[38:41], v[14:17]
    ds_read_b64_tr_b16 v[46:47], v65 offset:32
    ds_read_b64_tr_b16 v[48:49], v65 offset:2336
    s_add_u32 m0, s56, 81920
    s_nop 0
    buffer_load_dwordx4 v67, s[36:39], s73 offen lds
    s_add_u32 s73, s73, s79
    s_waitcnt lgkmcnt(6)
    v_mfma_f32_16x16x32_bf16 v[18:21], v[50:53], v[34:37], v[18:21]
    v_mfma_f32_16x16x32_bf16 v[22:25], v[50:53], v[38:41], v[22:25]
    ds_read_b64_tr_b16 v[50:51], v65 offset:64
    ds_read_b64_tr_b16 v[52:53], v65 offset:2368
    s_cmp_eq_u32 s57, 1
    s_cbranch_scc1 L133_d
    s_add_u32 m0, s56, 94208
    s_nop 0
    buffer_load_dwordx4 v68, s[40:43], s74 offen lds
    s_add_u32 s74, s74, s80
L133_d:
    ds_read_b128 v[34:37], v61 offset:0
    ds_read_b128 v[38:41], v61 offset:2048
    s_waitcnt lgkmcnt(6)
    v_mfma_f32_16x16x32_bf16 v[2:5], v[42:45], v[26:29], v[2:5]
    v_mfma_f32_16x16x32_bf16 v[6:9], v[42:45], v[30:33], v[6:9]
    ds_read_b64_tr_b16 v[42:43], v65 offset:9216
    ds_read_b64_tr_b16 v[44:45], v65 offset:11520
    s_waitcnt lgkmcnt(6)
    v_mfma_f32_16x16x32_bf16 v[10:13], v[46:49], v[26:29], v[10:13]
    v_mfma_f32_16x16x32_bf16 v[14:17], v[46:49], v[30:33], v[14:17]
    ds_read_b64_tr_b16 v[46:47], v65 offset:9248
    ds_read_b64_tr_b16 v[48:49], v65 offset:11552
    s_waitcnt lgkmcnt(6)
    v_mfma_f32_16x16x32_bf16 v[18:21], v[50:53], v[26:29], v[18:21]
    v_mfma_f32_16x16x32_bf16 v[22:25], v[50:53], v[30:33], v[22:25]
    ds_read_b64_tr_b16 v[50:51], v65 offset:9280
    ds_read_b64_tr_b16 v[52:53], v65 offset:11584
    s_waitcnt lgkmcnt(0)
    s_cmp_eq_u32 s57, 1
    s_cbranch_scc1 L134_wa
    s_waitcnt vmcnt(6)
    s_branch L134_wb
L134_wa:
    s_waitcnt vmcnt(4)
L134_wb:
    s_barrier
    ds_read_b128 v[26:29], v54 offset:0
    ds_read_b128 v[30:33], v54 offset:2048
    s_waitcnt lgkmcnt(6)
    v_mfma_f32_16x16x32_bf16 v[2:5], v[42:45], v[34:37], v[2:5]
    v_mfma_f32_16x16x32_bf16 v[6:9], v[42:45], v[38:41], v[6:9]
    ds_read_b64_tr_b16 v[42:43], v62 offset:0
    ds_read_b64_tr_b16 v[44:45], v62 offset:2304
    s_add_u32 m0, s56, 104448
    s_nop 0
    buffer_load_dwordx4 v66, s[32:35], s72 offen lds
    s_add_u32 s72, s72, s78
    s_waitcnt lgkmcnt(6)
    v_mfma_f32_16x16x32_bf16 v[10:13], v[46:49], v[34:37], v[10:13]
    v_mfma_f32_16x16x32_bf16 v[14:17], v[46:49], v[38:41], v[14:17]
    ds_read_b64_tr_b16 v[46:47], v62 offset:32
    ds_read_b64_tr_b16 v[48:49], v62 offset:2336
    s_add_u32 m0, s56, 116736
    s_nop 0
    buffer_load_dwordx4 v67, s[36:39], s73 offen lds
    s_add_u32 s73, s73, s79
    s_waitcnt lgkmcnt(6)
    v_mfma_f32_16x16x32_bf16 v[18:21], v[50:53], v[34:37], v[18:21]
    v_mfma_f32_16x16x32_bf16 v[22:25], v[50:53], v[38:41], v[22:25]
    ds_read_b64_tr_b16 v[50:51], v62 offset:64
    ds_read_b64_tr_b16 v[52:53], v62 offset:2368
    s_cmp_eq_u32 s57, 1
    s_cbranch_scc1 L135_d
    s_add_u32 m0, s56, 129024
    s_nop 0
    buffer_load_dwordx4 v68, s[40:43], s74 offen lds
    s_add_u32 s74, s74, s80
L135_d:
    ds_read_b128 v[34:37], v55 offset:0
    ds_read_b128 v[38:41], v55 offset:2048
    s_waitcnt lgkmcnt(6)
    v_mfma_f32_16x16x32_bf16 v[2:5], v[42:45], v[26:29], v[2:5]
    v_mfma_f32_16x16x32_bf16 v[6:9], v[42:45], v[30:33], v[6:9]
    ds_read_b64_tr_b16 v[42:43], v62 offset:9216
    ds_read_b64_tr_b16 v[44:45], v62 offset:11520
    s_waitcnt lgkmcnt(6)
    v_mfma_f32_16x16x32_bf16 v[10:13], v[46:49], v[26:29], v[10:13]
    v_mfma_f32_16x16x32_bf16 v[14:17], v[46:49], v[30:33], v[14:17]
    ds_read_b64_tr_b16 v[46:47], v62 offset:9248
    ds_read_b64_tr_b16 v[48:49], v62 offset:11552
    s_waitcnt lgkmcnt(6)
    v_mfma_f32_16x16x32_bf16 v[18:21], v[50:53], v[26:29], v[18:21]
    v_mfma_f32_16x16x32_bf16 v[22:25], v[50:53], v[30:33], v[22:25]
    ds_read_b64_tr_b16 v[50:51], v62 offset:9280
    ds_read_b64_tr_b16 v[52:53], v62 offset:11584
    s_waitcnt lgkmcnt(0)
    s_cmp_eq_u32 s57, 1
    s_cbranch_scc1 L136_wa
    s_waitcnt vmcnt(6)
    s_branch L136_wb
L136_wa:
    s_waitcnt vmcnt(4)
L136_wb:
    s_barrier
    ds_read_b128 v[26:29], v56 offset:0
    ds_read_b128 v[30:33], v56 offset:2048
    s_waitcnt lgkmcnt(6)
    v_mfma_f32_16x16x32_bf16 v[2:5], v[42:45], v[34:37], v[2:5]
    v_mfma_f32_16x16x32_bf16 v[6:9], v[42:45], v[38:41], v[6:9]
    ds_read_b64_tr_b16 v[42:43], v63 offset:0
    ds_read_b64_tr_b16 v[44:45], v63 offset:2304
    s_add_u32 m0, s56, 0
    s_nop 0
    buffer_load_dwordx4 v66, s[32:35], s72 offen lds
    s_add_u32 s72, s72, s78
    s_waitcnt lgkmcnt(6)
    v_mfma_f32_16x16x32_bf16 v[10:13], v[46:49], v[34:37], v[10:13]
    v_mfma_f32_16x16x32_bf16 v[14:17], v[46:49], v[38:41], v[14:17]
    ds_read_b64_tr_b16 v[46:47], v63 offset:32
    ds_read_b64_tr_b16 v[48:49], v63 offset:2336
    s_add_u32 m0, s56, 12288
    s_nop 0
    buffer_load_dwordx4 v67, s[36:39], s73 offen lds
    s_add_u32 s73, s73, s79
    s_waitcnt lgkmcnt(6)
    v_mfma_f32_16x16x32_bf16 v[18:21], v[50:53], v[34:37], v[18:21]
    v_mfma_f32_16x16x32_bf16 v[22:25], v[50:53], v[38:41], v[22:25]
    ds_read_b64_tr_b16 v[50:51], v63 offset:64
    ds_read_b64_tr_b16 v[52:53], v63 offset:2368
    s_cmp_eq_u32 s57, 1
    s_cbranch_scc1 L137_d
    s_add_u32 m0, s56, 24576
    s_nop 0
    buffer_load_dwordx4 v68, s[40:43], s74 offen lds
    s_add_u32 s74, s74, s80
L137_d:
    ds_read_b128 v[34:37], v57 offset:0
    ds_read_b128 v[38:41], v57 offset:2048
    s_waitcnt lgkmcnt(6)
    v_mfma_f32_16x16x32_bf16 v[2:5], v[42:45], v[26:29], v[2:5]
    v_mfma_f32_16x16x32_bf16 v[6:9], v[42:45], v[30:33], v[6:9]
    ds_read_b64_tr_b16 v[42:43], v63 offset:9216
    ds_read_b64_tr_b16 v[44:45], v63 offset:11520
    s_waitcnt lgkmcnt(6)
    v_mfma_f32_16x16x32_bf16 v[10:13], v[46:49], v[26:29], v[10:13]
    v_mfma_f32_16x16x32_bf16 v[14:17], v[46:49], v[30:33], v[14:17]
    ds_read_b64_tr_b16 v[46:47], v63 offset:9248
    ds_read_b64_tr_b16 v[48:49], v63 offset:11552
    s_waitcnt lgkmcnt(6)
    v_mfma_f32_16x16x32_bf16 v[18:21], v[50:53], v[26:29], v[18:21]
    v_mfma_f32_16x16x32_bf16 v[22:25], v[50:53], v[30:33], v[22:25]
    ds_read_b64_tr_b16 v[50:51], v63 offset:9280
    ds_read_b64_tr_b16 v[52:53], v63 offset:11584
    s_waitcnt lgkmcnt(0)
    s_cmp_eq_u32 s57, 1
    s_cbranch_scc1 L138_wa
    s_waitcnt vmcnt(6)
    s_branch L138_wb
L138_wa:
    s_waitcnt vmcnt(4)
L138_wb:
    s_barrier
    ds_read_b128 v[26:29], v58 offset:0
    ds_read_b128 v[30:33], v58 offset:2048
    s_waitcnt lgkmcnt(6)
    v_mfma_f32_16x16x32_bf16 v[2:5], v[42:45], v[34:37], v[2:5]
    v_mfma_f32_16x16x32_bf16 v[6:9], v[42:45], v[38:41], v[6:9]
    ds_read_b64_tr_b16 v[42:43], v64 offset:0
    ds_read_b64_tr_b16 v[44:45], v64 offset:2304
    s_add_u32 m0, s56, 34816
    s_nop 0
    buffer_load_dwordx4 v66, s[32:35], s72 offen lds
    s_add_u32 s72, s72, s78
    s_waitcnt lgkmcnt(6)
    v_mfma_f32_16x16x32_bf16 v[10:13], v[46:49], v[34:37], v[10:13]
    v_mfma_f32_16x16x32_bf16 v[14:17], v[46:49], v[38:41], v[14:17]
    ds_read_b64_tr_b16 v[46:47], v64 offset:32
    ds_read_b64_tr_b16 v[48:49], v64 offset:2336
    s_add_u32 m0, s56, 47104
    s_nop 0
    buffer_load_dwordx4 v67, s[36:39], s73 offen lds
    s_add_u32 s73, s73, s79
    s_waitcnt lgkmcnt(6)
    v_mfma_f32_16x16x32_bf16 v[18:21], v[50:53], v[34:37], v[18:21]
    v_mfma_f32_16x16x32_bf16 v[22:25], v[50:53], v[38:41], v[22:25]
    ds_read_b64_tr_b16 v[50:51], v64 offset:64
    ds_read_b64_tr_b16 v[52:53], v64 offset:2368
    s_cmp_eq_u32 s57, 1
    s_cbranch_scc1 L139_d
    s_add_u32 m0, s56, 59392
    s_nop 0
    buffer_load_dwordx4 v68, s[40:43], s74 offen lds
    s_add_u32 s74, s74, s80
L139_d:
    ds_read_b128 v[34:37], v59 offset:0
    ds_read_b128 v[38:41], v59 offset:2048
    s_waitcnt lgkmcnt(6)
    v_mfma_f32_16x16x32_bf16 v[2:5], v[42:45], v[26:29], v[2:5]
    v_mfma_f32_16x16x32_bf16 v[6:9], v[42:45], v[30:33], v[6:9]
    ds_read_b64_tr_b16 v[42:43], v64 offset:9216
    ds_read_b64_tr_b16 v[44:45], v64 offset:11520
    s_waitcnt lgkmcnt(6)
    v_mfma_f32_16x16x32_bf16 v[10:13], v[46:49], v[26:29], v[10:13]
    v_mfma_f32_16x16x32_bf16 v[14:17], v[46:49], v[30:33], v[14:17]
    ds_read_b64_tr_b16 v[46:47], v64 offset:9248
    ds_read_b64_tr_b16 v[48:49], v64 offset:11552
    s_waitcnt lgkmcnt(6)
    v_mfma_f32_16x16x32_bf16 v[18:21], v[50:53], v[26:29], v[18:21]
    v_mfma_f32_16x16x32_bf16 v[22:25], v[50:53], v[30:33], v[22:25]
    ds_read_b64_tr_b16 v[50:51], v64 offset:9280
    ds_read_b64_tr_b16 v[52:53], v64 offset:11584
    s_waitcnt lgkmcnt(0)
    s_cmp_eq_u32 s57, 1
    s_cbranch_scc1 L140_wa
    s_waitcnt vmcnt(6)
    s_branch L140_wb
L140_wa:
    s_waitcnt vmcnt(4)
L140_wb:
    s_barrier
    ds_read_b128 v[26:29], v60 offset:0
    ds_read_b128 v[30:33], v60 offset:2048
    s_waitcnt lgkmcnt(6)
    v_mfma_f32_16x16x32_bf16 v[2:5], v[42:45], v[34:37], v[2:5]
    v_mfma_f32_16x16x32_bf16 v[6:9], v[42:45], v[38:41], v[6:9]
    ds_read_b64_tr_b16 v[42:43], v65 offset:0
    ds_read_b64_tr_b16 v[44:45], v65 offset:2304
    s_add_u32 m0, s56, 69632
    s_nop 0
    buffer_load_dwordx4 v66, s[32:35], s72 offen lds
    s_add_u32 s72, s72, s78
    s_waitcnt lgkmcnt(6)
    v_mfma_f32_16x16x32_bf16 v[10:13], v[46:49], v[34:37], v[10:13]
    v_mfma_f32_16x16x32_bf16 v[14:17], v[46:49], v[38:41], v[14:17]
    ds_read_b64_tr_b16 v[46:47], v65 offset:32
    ds_read_b64_tr_b16 v[48:49], v65 offset:2336
    s_add_u32 m0, s56, 81920
    s_nop 0
    buffer_load_dwordx4 v67, s[36:39], s73 offen lds
    s_add_u32 s73, s73, s79
    s_waitcnt lgkmcnt(6)
    v_mfma_f32_16x16x32_bf16 v[18:21], v[50:53], v[34:37], v[18:21]
    v_mfma_f32_16x16x32_bf16 v[22:25], v[50:53], v[38:41], v[22:25]
    ds_read_b64_tr_b16 v[50:51], v65 offset:64
    ds_read_b64_tr_b16 v[52:53], v65 offset:2368
    s_cmp_eq_u32 s57, 1
    s_cbranch_scc1 L141_d
    s_add_u32 m0, s56, 94208
    s_nop 0
    buffer_load_dwordx4 v68, s[40:43], s74 offen lds
    s_add_u32 s74, s74, s80
L141_d:
    ds_read_b128 v[34:37], v61 offset:0
    ds_read_b128 v[38:41], v61 offset:2048
    s_waitcnt lgkmcnt(6)
    v_mfma_f32_16x16x32_bf16 v[2:5], v[42:45], v[26:29], v[2:5]
    v_mfma_f32_16x16x32_bf16 v[6:9], v[42:45], v[30:33], v[6:9]
    ds_read_b64_tr_b16 v[42:43], v65 offset:9216
    ds_read_b64_tr_b16 v[44:45], v65 offset:11520
    s_waitcnt lgkmcnt(6)
    v_mfma_f32_16x16x32_bf16 v[10:13], v[46:49], v[26:29], v[10:13]
    v_mfma_f32_16x16x32_bf16 v[14:17], v[46:49], v[30:33], v[14:17]
    ds_read_b64_tr_b16 v[46:47], v65 offset:9248
    ds_read_b64_tr_b16 v[48:49], v65 offset:11552
    s_waitcnt lgkmcnt(6)
    v_mfma_f32_16x16x32_bf16 v[18:21], v[50:53], v[26:29], v[18:21]
    v_mfma_f32_16x16x32_bf16 v[22:25], v[50:53], v[30:33], v[22:25]
    ds_read_b64_tr_b16 v[50:51], v65 offset:9280
    ds_read_b64_tr_b16 v[52:53], v65 offset:11584
    s_waitcnt lgkmcnt(0)
    s_cmp_eq_u32 s57, 1
    s_cbranch_scc1 L142_wa
    s_waitcnt vmcnt(6)
    s_branch L142_wb
L142_wa:
    s_waitcnt vmcnt(4)
L142_wb:
    s_barrier
    ds_read_b128 v[26:29], v54 offset:0
    ds_read_b128 v[30:33], v54 offset:2048
    s_waitcnt lgkmcnt(6)
    v_mfma_f32_16x16x32_bf16 v[2:5], v[42:45], v[34:37], v[2:5]
    v_mfma_f32_16x16x32_bf16 v[6:9], v[42:45], v[38:41], v[6:9]
    ds_read_b64_tr_b16 v[42:43], v62 offset:0
    ds_read_b64_tr_b16 v[44:45], v62 offset:2304
    s_add_u32 m0, s56, 104448
    s_nop 0
    buffer_load_dwordx4 v66, s[32:35], s72 offen lds
    s_add_u32 s72, s72, s78
    s_waitcnt lgkmcnt(6)
    v_mfma_f32_16x16x32_bf16 v[10:13], v[46:49], v[34:37], v[10:13]
    v_mfma_f32_16x16x32_bf16 v[14:17], v[46:49], v[38:41], v[14:17]
    ds_read_b64_tr_b16 v[46:47], v62 offset:32
    ds_read_b64_tr_b16 v[48:49], v62 offset:2336
    s_add_u32 m0, s56, 116736
    s_nop 0
    buffer_load_dwordx4 v67, s[36:39], s73 offen lds
    s_add_u32 s73, s73, s79
    s_waitcnt lgkmcnt(6)
    v_mfma_f32_16x16x32_bf16 v[18:21], v[50:53], v[34:37], v[18:21]
    v_mfma_f32_16x16x32_bf16 v[22:25], v[50:53], v[38:41], v[22:25]
    ds_read_b64_tr_b16 v[50:51], v62 offset:64
    ds_read_b64_tr_b16 v[52:53], v62 offset:2368
    s_cmp_eq_u32 s57, 1
    s_cbranch_scc1 L143_d
    s_add_u32 m0, s56, 129024
    s_nop 0
    buffer_load_dwordx4 v68, s[40:43], s74 offen lds
    s_add_u32 s74, s74, s80
L143_d:
    ds_read_b128 v[34:37], v55 offset:0
    ds_read_b128 v[38:41], v55 offset:2048
    s_waitcnt lgkmcnt(6)
    v_mfma_f32_16x16x32_bf16 v[2:5], v[42:45], v[26:29], v[2:5]
    v_mfma_f32_16x16x32_bf16 v[6:9], v[42:45], v[30:33], v[6:9]
    ds_read_b64_tr_b16 v[42:43], v62 offset:9216
    ds_read_b64_tr_b16 v[44:45], v62 offset:11520
    s_waitcnt lgkmcnt(6)
    v_mfma_f32_16x16x32_bf16 v[10:13], v[46:49], v[26:29], v[10:13]
    v_mfma_f32_16x16x32_bf16 v[14:17], v[46:49], v[30:33], v[14:17]
    ds_read_b64_tr_b16 v[46:47], v62 offset:9248
    ds_read_b64_tr_b16 v[48:49], v62 offset:11552
    s_waitcnt lgkmcnt(6)
    v_mfma_f32_16x16x32_bf16 v[18:21], v[50:53], v[26:29], v[18:21]
    v_mfma_f32_16x16x32_bf16 v[22:25], v[50:53], v[30:33], v[22:25]
    ds_read_b64_tr_b16 v[50:51], v62 offset:9280
    ds_read_b64_tr_b16 v[52:53], v62 offset:11584
    s_waitcnt lgkmcnt(0)
    s_cmp_eq_u32 s57, 1
    s_cbranch_scc1 L144_wa
    s_waitcnt vmcnt(6)
    s_branch L144_wb
L144_wa:
    s_waitcnt vmcnt(4)
L144_wb:
    s_barrier
    ds_read_b128 v[26:29], v56 offset:0
    ds_read_b128 v[30:33], v56 offset:2048
    s_waitcnt lgkmcnt(6)
    v_mfma_f32_16x16x32_bf16 v[2:5], v[42:45], v[34:37], v[2:5]
    v_mfma_f32_16x16x32_bf16 v[6:9], v[42:45], v[38:41], v[6:9]
    ds_read_b64_tr_b16 v[42:43], v63 offset:0
    ds_read_b64_tr_b16 v[44:45], v63 offset:2304
    s_add_u32 m0, s56, 0
    s_nop 0
    buffer_load_dwordx4 v66, s[32:35], s72 offen lds
    s_add_u32 s72, s72, s78
    s_waitcnt lgkmcnt(6)
    v_mfma_f32_16x16x32_bf16 v[10:13], v[46:49], v[34:37], v[10:13]
    v_mfma_f32_16x16x32_bf16 v[14:17], v[46:49], v[38:41], v[14:17]
    ds_read_b64_tr_b16 v[46:47], v63 offset:32
    ds_read_b64_tr_b16 v[48:49], v63 offset:2336
    s_add_u32 m0, s56, 12288
    s_nop 0
    buffer_load_dwordx4 v67, s[36:39], s73 offen lds
    s_add_u32 s73, s73, s79
    s_waitcnt lgkmcnt(6)
    v_mfma_f32_16x16x32_bf16 v[18:21], v[50:53], v[34:37], v[18:21]
    v_mfma_f32_16x16x32_bf16 v[22:25], v[50:53], v[38:41], v[22:25]
    ds_read_b64_tr_b16 v[50:51], v63 offset:64
    ds_read_b64_tr_b16 v[52:53], v63 offset:2368
    s_cmp_eq_u32 s57, 1
    s_cbranch_scc1 L145_d
    s_add_u32 m0, s56, 24576
    s_nop 0
    buffer_load_dwordx4 v68, s[40:43], s74 offen lds
    s_add_u32 s74, s74, s80
L145_d:
    ds_read_b128 v[34:37], v57 offset:0
    ds_read_b128 v[38:41], v57 offset:2048
    s_waitcnt lgkmcnt(6)
    v_mfma_f32_16x16x32_bf16 v[2:5], v[42:45], v[26:29], v[2:5]
    v_mfma_f32_16x16x32_bf16 v[6:9], v[42:45], v[30:33], v[6:9]
    ds_read_b64_tr_b16 v[42:43], v63 offset:9216
    ds_read_b64_tr_b16 v[44:45], v63 offset:11520
    s_waitcnt lgkmcnt(6)
    v_mfma_f32_16x16x32_bf16 v[10:13], v[46:49], v[26:29], v[10:13]
    v_mfma_f32_16x16x32_bf16 v[14:17], v[46:49], v[30:33], v[14:17]
    ds_read_b64_tr_b16 v[46:47], v63 offset:9248
    ds_read_b64_tr_b16 v[48:49], v63 offset:11552
    s_waitcnt lgkmcnt(6)
    v_mfma_f32_16x16x32_bf16 v[18:21], v[50:53], v[26:29], v[18:21]
    v_mfma_f32_16x16x32_bf16 v[22:25], v[50:53], v[30:33], v[22:25]
    ds_read_b64_tr_b16 v[50:51], v63 offset:9280
    ds_read_b64_tr_b16 v[52:53], v63 offset:11584
    s_waitcnt lgkmcnt(0)
    s_cmp_eq_u32 s57, 1
    s_cbranch_scc1 L146_wa
    s_waitcnt vmcnt(6)
    s_branch L146_wb
L146_wa:
    s_waitcnt vmcnt(4)
L146_wb:
    s_barrier
    ds_read_b128 v[26:29], v58 offset:0
    ds_read_b128 v[30:33], v58 offset:2048
    s_waitcnt lgkmcnt(6)
    v_mfma_f32_16x16x32_bf16 v[2:5], v[42:45], v[34:37], v[2:5]
    v_mfma_f32_16x16x32_bf16 v[6:9], v[42:45], v[38:41], v[6:9]
    ds_read_b64_tr_b16 v[42:43], v64 offset:0
    ds_read_b64_tr_b16 v[44:45], v64 offset:2304
    s_add_u32 m0, s56, 34816
    s_nop 0
    buffer_load_dwordx4 v66, s[32:35], s72 offen lds
    s_add_u32 s72, s72, s78
    s_waitcnt lgkmcnt(6)
    v_mfma_f32_16x16x32_bf16 v[10:13], v[46:49], v[34:37], v[10:13]
    v_mfma_f32_16x16x32_bf16 v[14:17], v[46:49], v[38:41], v[14:17]
    ds_read_b64_tr_b16 v[46:47], v64 offset:32
    ds_read_b64_tr_b16 v[48:49], v64 offset:2336
    s_add_u32 m0, s56, 47104
    s_nop 0
    buffer_load_dwordx4 v67, s[36:39], s73 offen lds
    s_add_u32 s73, s73, s79
    s_waitcnt lgkmcnt(6)
    v_mfma_f32_16x16x32_bf16 v[18:21], v[50:53], v[34:37], v[18:21]
    v_mfma_f32_16x16x32_bf16 v[22:25], v[50:53], v[38:41], v[22:25]
    ds_read_b64_tr_b16 v[50:51], v64 offset:64
    ds_read_b64_tr_b16 v[52:53], v64 offset:2368
    s_cmp_eq_u32 s57, 1
    s_cbranch_scc1 L147_d
    s_add_u32 m0, s56, 59392
    s_nop 0
    buffer_load_dwordx4 v68, s[40:43], s74 offen lds
    s_add_u32 s74, s74, s80
L147_d:
    ds_read_b128 v[34:37], v59 offset:0
    ds_read_b128 v[38:41], v59 offset:2048
    s_waitcnt lgkmcnt(6)
    v_mfma_f32_16x16x32_bf16 v[2:5], v[42:45], v[26:29], v[2:5]
    v_mfma_f32_16x16x32_bf16 v[6:9], v[42:45], v[30:33], v[6:9]
    ds_read_b64_tr_b16 v[42:43], v64 offset:9216
    ds_read_b64_tr_b16 v[44:45], v64 offset:11520
    s_waitcnt lgkmcnt(6)
    v_mfma_f32_16x16x32_bf16 v[10:13], v[46:49], v[26:29], v[10:13]
    v_mfma_f32_16x16x32_bf16 v[14:17], v[46:49], v[30:33], v[14:17]
    ds_read_b64_tr_b16 v[46:47], v64 offset:9248
    ds_read_b64_tr_b16 v[48:49], v64 offset:11552
    s_waitcnt lgkmcnt(6)
    v_mfma_f32_16x16x32_bf16 v[18:21], v[50:53], v[26:29], v[18:21]
    v_mfma_f32_16x16x32_bf16 v[22:25], v[50:53], v[30:33], v[22:25]
    ds_read_b64_tr_b16 v[50:51], v64 offset:9280
    ds_read_b64_tr_b16 v[52:53], v64 offset:11584
    s_waitcnt lgkmcnt(0)
    s_cmp_eq_u32 s57, 1
    s_cbranch_scc1 L148_wa
    s_waitcnt vmcnt(6)
    s_branch L148_wb
L148_wa:
    s_waitcnt vmcnt(4)
L148_wb:
    s_barrier
    ds_read_b128 v[26:29], v60 offset:0
    ds_read_b128 v[30:33], v60 offset:2048
    s_waitcnt lgkmcnt(6)
    v_mfma_f32_16x16x32_bf16 v[2:5], v[42:45], v[34:37], v[2:5]
    v_mfma_f32_16x16x32_bf16 v[6:9], v[42:45], v[38:41], v[6:9]
    ds_read_b64_tr_b16 v[42:43], v65 offset:0
    ds_read_b64_tr_b16 v[44:45], v65 offset:2304
    s_waitcnt lgkmcnt(6)
    v_mfma_f32_16x16x32_bf16 v[10:13], v[46:49], v[34:37], v[10:13]
    v_mfma_f32_16x16x32_bf16 v[14:17], v[46:49], v[38:41], v[14:17]
    ds_read_b64_tr_b16 v[46:47], v65 offset:32
    ds_read_b64_tr_b16 v[48:49], v65 offset:2336
    s_waitcnt lgkmcnt(6)
    v_mfma_f32_16x16x32_bf16 v[18:21], v[50:53], v[34:37], v[18:21]
    v_mfma_f32_16x16x32_bf16 v[22:25], v[50:53], v[38:41], v[22:25]
    ds_read_b64_tr_b16 v[50:51], v65 offset:64
    ds_read_b64_tr_b16 v[52:53], v65 offset:2368
    ds_read_b128 v[34:37], v61 offset:0
    ds_read_b128 v[38:41], v61 offset:2048
    s_waitcnt lgkmcnt(6)
    v_mfma_f32_16x16x32_bf16 v[2:5], v[42:45], v[26:29], v[2:5]
    v_mfma_f32_16x16x32_bf16 v[6:9], v[42:45], v[30:33], v[6:9]
    ds_read_b64_tr_b16 v[42:43], v65 offset:9216
    ds_read_b64_tr_b16 v[44:45], v65 offset:11520
    s_waitcnt lgkmcnt(6)
    v_mfma_f32_16x16x32_bf16 v[10:13], v[46:49], v[26:29], v[10:13]
    v_mfma_f32_16x16x32_bf16 v[14:17], v[46:49], v[30:33], v[14:17]
    ds_read_b64_tr_b16 v[46:47], v65 offset:9248
    ds_read_b64_tr_b16 v[48:49], v65 offset:11552
    s_waitcnt lgkmcnt(6)
    v_mfma_f32_16x16x32_bf16 v[18:21], v[50:53], v[26:29], v[18:21]
    v_mfma_f32_16x16x32_bf16 v[22:25], v[50:53], v[30:33], v[22:25]
    ds_read_b64_tr_b16 v[50:51], v65 offset:9280
    ds_read_b64_tr_b16 v[52:53], v65 offset:11584
    s_waitcnt lgkmcnt(0)
    s_cmp_eq_u32 s57, 1
    s_cbranch_scc1 L149_wa
    s_waitcnt vmcnt(3)
    s_branch L149_wb
L149_wa:
    s_waitcnt vmcnt(2)
L149_wb:
    s_barrier
    ds_read_b128 v[26:29], v54 offset:0
    ds_read_b128 v[30:33], v54 offset:2048
    s_waitcnt lgkmcnt(6)
    v_mfma_f32_16x16x32_bf16 v[2:5], v[42:45], v[34:37], v[2:5]
    v_mfma_f32_16x16x32_bf16 v[6:9], v[42:45], v[38:41], v[6:9]
    ds_read_b64_tr_b16 v[42:43], v62 offset:0
    ds_read_b64_tr_b16 v[44:45], v62 offset:2304
    s_waitcnt lgkmcnt(6)
    v_mfma_f32_16x16x32_bf16 v[10:13], v[46:49], v[34:37], v[10:13]
    v_mfma_f32_16x16x32_bf16 v[14:17], v[46:49], v[38:41], v[14:17]
    ds_read_b64_tr_b16 v[46:47], v62 offset:32
    ds_read_b64_tr_b16 v[48:49], v62 offset:2336
    s_waitcnt lgkmcnt(6)
    v_mfma_f32_16x16x32_bf16 v[18:21], v[50:53], v[34:37], v[18:21]
    v_mfma_f32_16x16x32_bf16 v[22:25], v[50:53], v[38:41], v[22:25]
    ds_read_b64_tr_b16 v[50:51], v62 offset:64
    ds_read_b64_tr_b16 v[52:53], v62 offset:2368
    ds_read_b128 v[34:37], v55 offset:0
    ds_read_b128 v[38:41], v55 offset:2048
    s_waitcnt lgkmcnt(6)
    v_mfma_f32_16x16x32_bf16 v[2:5], v[42:45], v[26:29], v[2:5]
    v_mfma_f32_16x16x32_bf16 v[6:9], v[42:45], v[30:33], v[6:9]
    ds_read_b64_tr_b16 v[42:43], v62 offset:9216
    ds_read_b64_tr_b16 v[44:45], v62 offset:11520
    s_waitcnt lgkmcnt(6)
    v_mfma_f32_16x16x32_bf16 v[10:13], v[46:49], v[26:29], v[10:13]
    v_mfma_f32_16x16x32_bf16 v[14:17], v[46:49], v[30:33], v[14:17]
    ds_read_b64_tr_b16 v[46:47], v62 offset:9248
    ds_read_b64_tr_b16 v[48:49], v62 offset:11552
    s_waitcnt lgkmcnt(6)
    v_mfma_f32_16x16x32_bf16 v[18:21], v[50:53], v[26:29], v[18:21]
    v_mfma_f32_16x16x32_bf16 v[22:25], v[50:53], v[30:33], v[22:25]
    ds_read_b64_tr_b16 v[50:51], v62 offset:9280
    ds_read_b64_tr_b16 v[52:53], v62 offset:11584
    s_waitcnt lgkmcnt(0)
    s_waitcnt vmcnt(0)
    s_barrier
    ds_read_b128 v[26:29], v56 offset:0
    ds_read_b128 v[30:33], v56 offset:2048
    s_waitcnt lgkmcnt(6)
    v_mfma_f32_16x16x32_bf16 v[2:5], v[42:45], v[34:37], v[2:5]
    v_mfma_f32_16x16x32_bf16 v[6:9], v[42:45], v[38:41], v[6:9]
    ds_read_b64_tr_b16 v[42:43], v63 offset:0
    ds_read_b64_tr_b16 v[44:45], v63 offset:2304
    s_waitcnt lgkmcnt(6)
    v_mfma_f32_16x16x32_bf16 v[10:13], v[46:49], v[34:37], v[10:13]
    v_mfma_f32_16x16x32_bf16 v[14:17], v[46:49], v[38:41], v[14:17]
    ds_read_b64_tr_b16 v[46:47], v63 offset:32
    ds_read_b64_tr_b16 v[48:49], v63 offset:2336
    s_waitcnt lgkmcnt(6)
    v_mfma_f32_16x16x32_bf16 v[18:21], v[50:53], v[34:37], v[18:21]
    v_mfma_f32_16x16x32_bf16 v[22:25], v[50:53], v[38:41], v[22:25]
    ds_read_b64_tr_b16 v[50:51], v63 offset:64
    ds_read_b64_tr_b16 v[52:53], v63 offset:2368
    ds_read_b128 v[34:37], v57 offset:0
    ds_read_b128 v[38:41], v57 offset:2048
    s_waitcnt lgkmcnt(6)
    v_mfma_f32_16x16x32_bf16 v[2:5], v[42:45], v[26:29], v[2:5]
    v_mfma_f32_16x16x32_bf16 v[6:9], v[42:45], v[30:33], v[6:9]
    ds_read_b64_tr_b16 v[42:43], v63 offset:9216
    ds_read_b64_tr_b16 v[44:45], v63 offset:11520
    s_waitcnt lgkmcnt(6)
    v_mfma_f32_16x16x32_bf16 v[10:13], v[46:49], v[26:29], v[10:13]
    v_mfma_f32_16x16x32_bf16 v[14:17], v[46:49], v[30:33], v[14:17]
    ds_read_b64_tr_b16 v[46:47], v63 offset:9248
    ds_read_b64_tr_b16 v[48:49], v63 offset:11552
    s_waitcnt lgkmcnt(6)
    v_mfma_f32_16x16x32_bf16 v[18:21], v[50:53], v[26:29], v[18:21]
    v_mfma_f32_16x16x32_bf16 v[22:25], v[50:53], v[30:33], v[22:25]
    ds_read_b64_tr_b16 v[50:51], v63 offset:9280
    ds_read_b64_tr_b16 v[52:53], v63 offset:11584
    s_waitcnt lgkmcnt(4)
    v_mfma_f32_16x16x32_bf16 v[2:5], v[42:45], v[34:37], v[2:5]
    v_mfma_f32_16x16x32_bf16 v[6:9], v[42:45], v[38:41], v[6:9]
    s_waitcnt lgkmcnt(2)
    v_mfma_f32_16x16x32_bf16 v[10:13], v[46:49], v[34:37], v[10:13]
    v_mfma_f32_16x16x32_bf16 v[14:17], v[46:49], v[38:41], v[14:17]
    s_waitcnt lgkmcnt(0)
    v_mfma_f32_16x16x32_bf16 v[18:21], v[50:53], v[34:37], v[18:21]
    v_mfma_f32_16x16x32_bf16 v[22:25], v[50:53], v[38:41], v[22:25]
    s_lshl_b32 s4, s68, 7
    s_mul_i32 s5, s62, 32
    s_add_u32 s4, s4, s5
    v_and_b32 v1, 15, v0
    v_add_u32 v1, s4, v1
    v_mul_u32_u24 v1, 2304, v1
    s_mul_i32 s4, s69, 576
    s_mul_i32 s5, s63, 192
    s_add_u32 s4, s4, s5
    s_mul_i32 s5, s70, 4718592
    s_add_u32 s4, s4, s5
    v_lshrrev_b32 v42, 4, v0
    v_lshlrev_b32 v42, 4, v42
    v_add3_u32 v1, v1, v42, s4
    buffer_store_dwordx4 v[2:5], v1, s[20:23], 0 offen offset:0 sc1
    buffer_store_dwordx4 v[10:13], v1, s[20:23], 0 offen offset:64 sc1
    buffer_store_dwordx4 v[18:21], v1, s[20:23], 0 offen offset:128 sc1
    v_add_u32 v1, 36864, v1
    buffer_store_dwordx4 v[6:9], v1, s[20:23], 0 offen offset:0 sc1
    buffer_store_dwordx4 v[14:17], v1, s[20:23], 0 offen offset:64 sc1
    buffer_store_dwordx4 v[22:25], v1, s[20:23], 0 offen offset:128 sc1
L122_done:
    s_mov_b64 exec, -1
    s_lshl_b32 s59, s68, 4
    s_lshl_b32 s4, s70, 2
    s_add_u32 s59, s59, s4
    s_add_u32 s59, s59, s69
    s_mov_b32 s31, s59
    s_cmp_lg_u32 s99, 0
    s_cbranch_scc1 layers_done
    s_mov_b32 s99, 32768
    s_add_u32 s28, s28, 67108864
    s_addc_u32 s29, s29, 0
    s_branch layer_top
layers_done:
    s_waitcnt vmcnt(0)
    s_barrier
    s_cmp_lg_u32 s3, 0
    s_cbranch_scc1 L150_pub
    s_lshl_b32 s4, s31, 7
    s_add_u32 s4, s4, 262144
    s_add_u32 s4, s4, s99
    v_mov_b32 v1, s4
    v_mov_b32 v2, s100
    v_mov_b32 v3, s101
    s_mov_b64 exec, 1
    buffer_store_dwordx2 v[2:3], v1, s[88:91], 0 offen sc1
    s_mov_b64 exec, -1
L150_pub:
    s_load_dwordx2 s[6:7], s[0:1], 56
    s_lshr_b32 s60, s2, 4
    s_lshl_b32 s60, s60, 4
    s_waitcnt lgkmcnt(0)
    s_mov_b32 s20, s6
    s_and_b32 s21, s7, 0xffff
    s_mov_b32 s22, 2359296
    s_mov_b32 s23, 0x00020000
    s_cmp_lg_u32 s3, 0
    s_cbranch_scc1 L151_polln
    s_mov_b32 s6, 65535
    s_mov_b32 s7, 0
    s_mov_b64 exec, s[6:7]
    v_add_u32 v1, s60, v0
    v_lshlrev_b32 v1, 7, v1
    v_add_u32 v1, 262144, v1
    v_add_u32 v1, s99, v1
    s_mov_b32 s5, 0
L151_poll:
    buffer_load_dwordx2 v[2:3], v1, s[88:91], 0 offen sc1
    s_waitcnt vmcnt(0)
    v_cmp_ne_u64 vcc, s[100:101], v[2:3]
    s_add_u32 s5, s5, 1
    s_cmp_gt_u32 s5, 0x40000
    s_cbranch_scc1 L151_pollx
    s_cbranch_vccz L151_pollx
    s_sleep 1
    s_branch L151_poll
L151_pollx:
    s_mov_b64 exec, -1
L151_polln:
    s_barrier
    s_cmp_ge_u32 s3, 8
    s_cbranch_scc1 L152_fin
    s_add_u32 s84, s28, 12582912
    s_addc_u32 s85, s29, 0
    s_and_b32 s85, s85, 0xffff
    s_mov_b32 s86, 2359296
    s_mov_b32 s87, 0x00020000
    s_add_u32 s24, s28, 37748736
    s_addc_u32 s25, s29, 0
    s_and_b32 s25, s25, 0xffff
    s_mov_b32 s26, 18874368
    s_mov_b32 s27, 0x00020000
    s_lshl_b32 s58, s2, 3
    s_add_u32 s58, s58, s3
    s_mul_i32 s64, s58, 1152
    v_lshlrev_b32 v2, 4, v0
    v_mov_b32 v8, 0
    v_mov_b32 v9, 0
    v_mov_b32 v10, 0
    v_mov_b32 v11, 0
    buffer_load_dwordx4 v[4:7], v2, s[84:87], s64 offen
    s_mul_i32 s65, s58, 2304
    v_lshlrev_b32 v3, 5, v0
    v_mov_b32 v40, 0
    v_mov_b32 v41, 0
    v_mov_b32 v42, 0
    v_mov_b32 v43, 0
    v_mov_b32 v44, 0
    v_mov_b32 v45, 0
    v_mov_b32 v46, 0
    v_mov_b32 v47, 0
    v_mov_b32 v56, 0
    v_mov_b32 v57, 0
    v_mov_b32 v58, 0
    v_mov_b32 v59, 0
    v_mov_b32 v60, 0
    v_mov_b32 v61, 0
    v_mov_b32 v62, 0
    v_mov_b32 v63, 0
    v_mov_b32 v72, 0
    v_mov_b32 v73, 0
    v_mov_b32 v74, 0
    v_mov_b32 v75, 0
    v_mov_b32 v76, 0
    v_mov_b32 v77, 0
    v_mov_b32 v78, 0
    v_mov_b32 v79, 0
    v_mov_b32 v88, 0
    v_mov_b32 v89, 0
    v_mov_b32 v90, 0
    v_mov_b32 v91, 0
    v_mov_b32 v92, 0
    v_mov_b32 v93, 0
    v_mov_b32 v94, 0
    v_mov_b32 v95, 0
    s_add_u32 s66, s65, 0
    buffer_load_dwordx4 v[32:35], v3, s[24:27], s66 offen
    buffer_load_dwordx4 v[36:39], v3, s[24:27], s66 offen offset:16
    s_add_u32 s67, s65, 4718592
    buffer_load_dwordx4 v[48:51], v3, s[24:27], s67 offen
    buffer_load_dwordx4 v[52:55], v3, s[24:27], s67 offen offset:16
    s_add_u32 s68, s65, 9437184
    buffer_load_dwordx4 v[64:67], v3, s[24:27], s68 offen
    buffer_load_dwordx4 v[68:71], v3, s[24:27], s68 offen offset:16
    s_add_u32 s69, s65, 14155776
    buffer_load_dwordx4 v[80:83], v3, s[24:27], s69 offen
    buffer_load_dwordx4 v[84:87], v3, s[24:27], s69 offen offset:16
    s_mov_b64 exec, 0xff
    buffer_load_dwordx4 v[8:11], v2, s[84:87], s64 offen offset:1024
    buffer_load_dwordx4 v[40:43], v3, s[24:27], s66 offen offset:2048
    buffer_load_dwordx4 v[44:47], v3, s[24:27], s66 offen offset:2064
    buffer_load_dwordx4 v[56:59], v3, s[24:27], s67 offen offset:2048
    buffer_load_dwordx4 v[60:63], v3, s[24:27], s67 offen offset:2064
    buffer_load_dwordx4 v[72:75], v3, s[24:27], s68 offen offset:2048
    buffer_load_dwordx4 v[76:79], v3, s[24:27], s68 offen offset:2064
    buffer_load_dwordx4 v[88:91], v3, s[24:27], s69 offen offset:2048
    buffer_load_dwordx4 v[92:95], v3, s[24:27], s69 offen offset:2064
    s_mov_b64 exec, -1
    s_waitcnt vmcnt(0)
    v_lshlrev_b32 v16, 16, v4
    v_and_b32 v17, 0xffff0000, v4
    v_lshlrev_b32 v18, 16, v5
    v_and_b32 v19, 0xffff0000, v5
    v_lshlrev_b32 v20, 16, v6
    v_and_b32 v21, 0xffff0000, v6
    v_lshlrev_b32 v22, 16, v7
    v_and_b32 v23, 0xffff0000, v7
    v_lshlrev_b32 v24, 16, v8
    v_and_b32 v25, 0xffff0000, v8
    v_lshlrev_b32 v26, 16, v9
    v_and_b32 v27, 0xffff0000, v9
    v_lshlrev_b32 v28, 16, v10
    v_and_b32 v29, 0xffff0000, v10
    v_lshlrev_b32 v30, 16, v11
    v_and_b32 v31, 0xffff0000, v11
    v_add_f32 v32, v32, v48
    v_add_f32 v32, v32, v64
    v_add_f32 v32, v32, v80
    v_add_f32 v33, v33, v49
    v_add_f32 v33, v33, v65
    v_add_f32 v33, v33, v81
    v_add_f32 v34, v34, v50
    v_add_f32 v34, v34, v66
    v_add_f32 v34, v34, v82
    v_add_f32 v35, v35, v51
    v_add_f32 v35, v35, v67
    v_add_f32 v35, v35, v83
    v_add_f32 v36, v36, v52
    v_add_f32 v36, v36, v68
    v_add_f32 v36, v36, v84
    v_add_f32 v37, v37, v53
    v_add_f32 v37, v37, v69
    v_add_f32 v37, v37, v85
    v_add_f32 v38, v38, v54
    v_add_f32 v38, v38, v70
    v_add_f32 v38, v38, v86
    v_add_f32 v39, v39, v55
    v_add_f32 v39, v39, v71
    v_add_f32 v39, v39, v87
    v_add_f32 v40, v40, v56
    v_add_f32 v40, v40, v72
    v_add_f32 v40, v40, v88
    v_add_f32 v41, v41, v57
    v_add_f32 v41, v41, v73
    v_add_f32 v41, v41, v89
    v_add_f32 v42, v42, v58
    v_add_f32 v42, v42, v74
    v_add_f32 v42, v42, v90
    v_add_f32 v43, v43, v59
    v_add_f32 v43, v43, v75
    v_add_f32 v43, v43, v91
    v_add_f32 v44, v44, v60
    v_add_f32 v44, v44, v76
    v_add_f32 v44, v44, v92
    v_add_f32 v45, v45, v61
    v_add_f32 v45, v45, v77
    v_add_f32 v45, v45, v93
    v_add_f32 v46, v46, v62
    v_add_f32 v46, v46, v78
    v_add_f32 v46, v46, v94
    v_add_f32 v47, v47, v63
    v_add_f32 v47, v47, v79
    v_add_f32 v47, v47, v95
    v_cvt_pk_bf16_f32 v4, v32, v33
    v_cvt_pk_bf16_f32 v5, v34, v35
    v_cvt_pk_bf16_f32 v6, v36, v37
    v_cvt_pk_bf16_f32 v7, v38, v39
    v_cvt_pk_bf16_f32 v8, v40, v41
    v_cvt_pk_bf16_f32 v9, v42, v43
    v_cvt_pk_bf16_f32 v10, v44, v45
    v_cvt_pk_bf16_f32 v11, v46, v47
    v_lshlrev_b32 v32, 16, v4
    v_and_b32 v33, 0xffff0000, v4
    v_lshlrev_b32 v34, 16, v5
    v_and_b32 v35, 0xffff0000, v5
    v_lshlrev_b32 v36, 16, v6
    v_and_b32 v37, 0xffff0000, v6
    v_lshlrev_b32 v38, 16, v7
    v_and_b32 v39, 0xffff0000, v7
    v_lshlrev_b32 v40, 16, v8
    v_and_b32 v41, 0xffff0000, v8
    v_lshlrev_b32 v42, 16, v9
    v_and_b32 v43, 0xffff0000, v9
    v_lshlrev_b32 v44, 16, v10
    v_and_b32 v45, 0xffff0000, v10
    v_lshlrev_b32 v46, 16, v11
    v_and_b32 v47, 0xffff0000, v11
    v_add_f32 v16, v16, v32
    v_add_f32 v17, v17, v33
    v_add_f32 v18, v18, v34
    v_add_f32 v19, v19, v35
    v_add_f32 v20, v20, v36
    v_add_f32 v21, v21, v37
    v_add_f32 v22, v22, v38
    v_add_f32 v23, v23, v39
    v_add_f32 v24, v24, v40
    v_add_f32 v25, v25, v41
    v_add_f32 v26, v26, v42
    v_add_f32 v27, v27, v43
    v_add_f32 v28, v28, v44
    v_add_f32 v29, v29, v45
    v_add_f32 v30, v30, v46
    v_add_f32 v31, v31, v47
    v_cvt_pk_bf16_f32 v4, v16, v17
    v_cvt_pk_bf16_f32 v5, v18, v19
    v_cvt_pk_bf16_f32 v6, v20, v21
    v_cvt_pk_bf16_f32 v7, v22, v23
    v_cvt_pk_bf16_f32 v8, v24, v25
    v_cvt_pk_bf16_f32 v9, v26, v27
    v_cvt_pk_bf16_f32 v10, v28, v29
    v_cvt_pk_bf16_f32 v11, v30, v31
    buffer_store_dwordx4 v[4:7], v2, s[20:23], s64 offen
    s_mov_b64 exec, 0xff
    buffer_store_dwordx4 v[8:11], v2, s[20:23], s64 offen offset:1024
    s_mov_b64 exec, -1
L152_fin:
interleave_layers__sliding_local_dilated__swiglu_ffn__prompt_kernel_end:
    s_endpgm
.section .rodata,"a"
.p2align 6
.amdhsa_kernel interleave_layers__sliding_local_dilated__swiglu_ffn__prompt_kernel
  .amdhsa_next_free_vgpr 166
  .amdhsa_next_free_sgpr 102
  .amdhsa_accum_offset 168
  .amdhsa_group_segment_fixed_size 0
  .amdhsa_kernarg_size 80
  .amdhsa_user_sgpr_count 2
  .amdhsa_user_sgpr_kernarg_segment_ptr 1
  .amdhsa_system_sgpr_workgroup_id_x 1
.end_amdhsa_kernel
```
